```python
import torch

def _softmax(x, axis=-1):
    return torch.softmax(x, dim=axis)
def _gelu(x):
    return torch.nn.functional.gelu(x, approximate="tanh")
def _silu(x):
    return torch.nn.functional.silu(x)
def _sigmoid(x):
    return torch.sigmoid(x)
def _layernorm(x, axis=-1, eps=1e-5):
    m = x.mean(dim=axis, keepdim=True)
    v = x.var(dim=axis, keepdim=True, unbiased=False)
    return (x - m) / torch.sqrt(v + eps)
def _scatter_add(tgt, idx, src, axis=0):
    return tgt.clone().index_add_(axis, idx, src)
def _segment_sum(src, seg, n):
    out = torch.zeros((n,) + src.shape[1:], dtype=src.dtype)
    return out.index_add_(0, seg, src)
def _pad(x, pw):
    flat = tuple(v for pair in reversed(pw) for v in pair)
    return torch.nn.functional.pad(x, flat)

kernel_name = 'recurrent_scan__gqa_block_cached__glu_gated_glu__decode'

def setup_inputs():

    _w = (lambda a: (lambda t: t.to(torch.bfloat16) if t.is_floating_point() else t)(torch.as_tensor(a)))
    def _A_setup():
        B, Sq, D = 1, 1, 512
        Hq, Hkv, Sk, Dh = 32, 8, 65536, 128
        assert Hq % Hkv == 0, (Hq, Hkv)
        return {
            "x": _w((lambda *s: torch.randn(*s, dtype=torch.bfloat16) * 0.05)(B, Sq, D)),
            "k_cache": _w((lambda *s: torch.randn(*s, dtype=torch.bfloat16) * 1.6)(B, Hkv, Sk, Dh)),
            "v_cache": _w((lambda *s: torch.randn(*s, dtype=torch.bfloat16) * 0.8)(B, Hkv, Sk, Dh)),
            "wq": _w((lambda *s: torch.randn(*s, dtype=torch.bfloat16) * 1.6)(D, Hq * Dh) * (D ** -0.5)),
            "wo": _w((lambda *s: torch.randn(*s, dtype=torch.bfloat16) * 0.8)(Hq * Dh, D) * ((Hq * Dh) ** -0.5)),
        }
    _A_in = _A_setup()

    def _B_setup():
        B, S, D, F = 1, 1, 512, 1792
        return {
            "x": _w((lambda *s: torch.randn(*s, dtype=torch.bfloat16) * 0.05)(B, S, D)),
            "w_gate": _w((lambda *s: torch.randn(*s, dtype=torch.bfloat16) * 0.8)(D, F)),
            "w_up": _w((lambda *s: torch.randn(*s, dtype=torch.bfloat16) * 0.2)(D, F)),
            "w_down": _w((lambda *s: torch.randn(*s, dtype=torch.bfloat16) * 0.2)(F, D)),
        }
    _B_in = _B_setup()

    return {
        "A_x": _A_in["x"],
        "A_k_cache": _A_in["k_cache"],
        "A_v_cache": _A_in["v_cache"],
        "A_wq": _A_in["wq"],
        "A_wo": _A_in["wo"],
        "B_x": _B_in["x"],
        "B_w_gate": _B_in["w_gate"],
        "B_w_up": _B_in["w_up"],
        "B_w_down": _B_in["w_down"],
    }

def reference(A_x, A_k_cache, A_v_cache, A_wq, A_wo, B_x, B_w_gate, B_w_up, B_w_down):
    def _A_ref(x, k_cache, v_cache, wq, wo):
        B, Sq, D = x.shape
        Hq, Dh = 32, 128
        Hkv = k_cache.shape[1]
        rep = Hq // Hkv
        q = (lambda x, *d: x.permute(*d))((x @ wq).reshape(B, Sq, Hq, Dh), 0, 2, 1, 3)
        k = (lambda x, n, axis: torch.repeat_interleave(x, n, dim=axis))(k_cache, rep, axis=1)
        v = (lambda x, n, axis: torch.repeat_interleave(x, n, dim=axis))(v_cache, rep, axis=1)
        scores = torch.einsum("bhqd,bhkd->bhqk", q, k) * (Dh ** -0.5)
        p = _softmax(scores, axis=-1)
        o = torch.einsum("bhqk,bhkd->bhqd", p, v)
        return (lambda x, *d: x.permute(*d))(o, 0, 2, 1, 3).reshape(B, Sq, Hq * Dh) @ wo

    def _B_ref(x, w_gate, w_up, w_down):
        g = torch.einsum("bsd,df->bsf", x, w_gate)
        u = torch.einsum("bsd,df->bsf", x, w_up)
        h = _sigmoid(g) * u
        return torch.einsum("bsf,fd->bsd", h, w_down)

    x = A_x
    xn = _layernorm(x, axis=-1)
    s = _A_ref(xn, A_k_cache, A_v_cache, A_wq, A_wo)
    g = _silu(_B_ref(xn, B_w_gate, B_w_up, B_w_down))
    return x + s * g
```

```asm
; @launch grid=(256,1,1) block=(320,1,1) lds=159744
.amdgcn_target "amdgcn-amd-amdhsa--gfx950"
.text
.globl recurrent_scan__gqa_block_cached__glu_gated_glu__decode_kernel
.p2align 8
.type recurrent_scan__gqa_block_cached__glu_gated_glu__decode_kernel,@function
recurrent_scan__gqa_block_cached__glu_gated_glu__decode_kernel:
    s_cmpk_ge_u32 s2, 0x100
    s_cbranch_scc1 L_end
    s_load_dwordx16 s[4:19], s[0:1], 0
    s_load_dwordx8 s[20:27], s[0:1], 64
    v_and_b32 v1, 63, v0
    v_readfirstlane_b32 s56, v0
    s_and_b32 s57, s2, 7
    s_lshr_b32 s58, s2, 3
    v_lshlrev_b32 v4, 4, v1
    v_lshrrev_b32 v2, 3, v1
    v_and_b32 v3, 0x70, v4
    s_mov_b32 s43, 0x20000
    s_lshr_b32 s56, s56, 6
    s_cbranch_scc1 L_e1
    s_and_b32 s71, s58, 7
    s_lshl3_add_u32 s71, s57, s71
    s_lshl_b32 s71, s71, 7
    s_lshr_b32 s72, s2, 6
    s_lshl_b32 s72, s72, 20
    s_add_u32 s71, s71, s72
    v_lshl_add_u32 v5, v2, 17, v3
    s_bfm_b32 s42, 1, 22
    s_movk_i32 m0, 4096
    s_waitcnt lgkmcnt(0)
    s_mov_b64 s[40:41], s[10:11]
L_wq:
    buffer_load_dwordx4 v5, s[40:43], s71 offen nt lds
    s_addk_i32 m0, 0x400
    s_addk_i32 s71, 0x2000
    s_cmpk_lt_u32 m0, 20480
    s_cbranch_scc1 L_wq
    s_branch L_e2
L_e1:
    s_cmp_lg_u32 s56, 2
    s_cbranch_scc1 L_e1b
    s_movk_i32 s42, 0x400
    s_waitcnt lgkmcnt(0)
    s_mov_b64 s[40:41], s[4:5]
    buffer_load_dwordx4 v[16:19], v4, s[40:43], 0 offen
L_e1b:
    s_cmp_lg_u32 s56, 1
    s_cbranch_scc1 L_e2
    s_getpc_b64 s[70:71]
L_pc:
    s_lshl_b32 s72, s58, 6
    v_add_u32 v5, s72, v1
    v_mul_u32_u24 v5, 12, v5
    v_min_u32 v5, L_end-L_pc, v5
    global_load_dword v16, v5, s[70:71]
    v_min_u32 v6, 20, v1
    s_mul_i32 s72, s58, 21
    s_lshl_b32 s73, s57, 10
    s_add_u32 s72, s72, s73
    v_add_lshl_u32 v6, v6, s72, 7
    s_waitcnt lgkmcnt(0)
    global_load_dword v17, v6, s[26:27] sc1
L_e2:
    v_and_b32 v6, 15, v1
    v_cmp_eq_u32 vcc, 3, v6
    v_lshlrev_b32 v6, 2, v6
    v_mov_b32 v7, 0
    v_cndmask_b32 v5, 0, 1, vcc
    ds_write_b32 v6, v5 offset:1024
    s_mov_b32 s70, 0x4040404
    s_mov_b32 s71, 0x33231303
    s_lshl_b32 s72, s57, 3
    s_lshr_b64 s[70:71], s[70:71], s72
    s_bfe_u32 s71, s70, 0x30004
    s_and_b32 s70, s70, 7
    s_lshr_b32 s72, s58, 3
    s_and_b32 s60, s58, 7
    s_lshl2_add_u32 s59, s57, s72
    s_sub_u32 s59, s59, s71
    s_cmp_lt_u32 s72, s70
    s_cselect_b32 s83, 1, 0
    s_mov_b32 s65, 0x05040100
    s_mov_b32 s66, 0x07060302
    s_mov_b32 s67, 0x3db504f3
    s_mov_b32 s68, 0x3fb8aa3b
    s_mov_b32 s69, 0xffff0000
    s_waitcnt lgkmcnt(0)
    s_barrier
    s_cmp_lg_u32 s56, 0
    s_cbranch_scc1 L_notloader
    v_mov_b32 v24, 8
    s_mul_i32 s73, s83, 0x1c0000
    s_mov_b32 s52, s20
    s_mov_b32 s53, s21
    s_mov_b32 s54, s73
    s_mov_b32 s55, 0x20000
    s_cmp_lt_u32 s60, 4
    s_cselect_b32 s44, s16, s18
    s_cselect_b32 s45, s17, s19
    s_mov_b32 s46, s73
    s_mov_b32 s47, 0x20000
    s_and_b32 s71, s60, 3
    s_mul_i32 s71, s71, 458752
    s_lshl_b32 s72, s59, 7
    s_add_u32 s71, s71, s72
    v_mul_u32_u24 v6, 57344, v2
    v_add_u32 v6, v6, v3
    s_mov_b32 m0, 143360
    s_add_u32 s72, s71, 0
    buffer_load_dwordx4 v6, s[44:47], s72 offen nt lds
    s_mov_b32 m0, 144384
    s_add_u32 s72, s71, 3584
    buffer_load_dwordx4 v6, s[44:47], s72 offen nt lds
    s_mov_b32 m0, 145408
    s_add_u32 s72, s71, 7168
    buffer_load_dwordx4 v6, s[44:47], s72 offen nt lds
    s_mov_b32 m0, 146432
    s_add_u32 s72, s71, 10752
    buffer_load_dwordx4 v6, s[44:47], s72 offen nt lds
    s_mov_b32 m0, 147456
    s_add_u32 s72, s71, 14336
    s_waitcnt vmcnt(19)
    buffer_load_dwordx4 v6, s[44:47], s72 offen nt lds
    s_mov_b32 m0, 148480
    s_add_u32 s72, s71, 17920
    s_waitcnt vmcnt(19)
    buffer_load_dwordx4 v6, s[44:47], s72 offen nt lds
    s_mov_b32 m0, 149504
    s_add_u32 s72, s71, 21504
    s_waitcnt vmcnt(19)
    buffer_load_dwordx4 v6, s[44:47], s72 offen nt lds
    s_mov_b32 m0, 150528
    s_add_u32 s72, s71, 25088
    s_waitcnt vmcnt(19)
    buffer_load_dwordx4 v6, s[44:47], s72 offen nt lds
    s_mov_b32 m0, 151552
    s_add_u32 s72, s71, 28672
    s_waitcnt vmcnt(19)
    buffer_load_dwordx4 v6, s[44:47], s72 offen nt lds
    s_mov_b32 m0, 152576
    s_add_u32 s72, s71, 32256
    s_waitcnt vmcnt(19)
    buffer_load_dwordx4 v6, s[44:47], s72 offen nt lds
    s_mov_b32 m0, 153600
    s_add_u32 s72, s71, 35840
    s_waitcnt vmcnt(19)
    buffer_load_dwordx4 v6, s[44:47], s72 offen nt lds
    s_mov_b32 m0, 154624
    s_add_u32 s72, s71, 39424
    s_waitcnt vmcnt(19)
    buffer_load_dwordx4 v6, s[44:47], s72 offen nt lds
    ds_write_b32 v7, v24 offset:1024
    v_add_u32 v24, 8, v24
    s_mov_b32 m0, 155648
    s_add_u32 s72, s71, 43008
    s_waitcnt vmcnt(19)
    buffer_load_dwordx4 v6, s[44:47], s72 offen nt lds
    s_mov_b32 m0, 156672
    s_add_u32 s72, s71, 46592
    s_waitcnt vmcnt(19)
    buffer_load_dwordx4 v6, s[44:47], s72 offen nt lds
    s_mov_b32 m0, 157696
    s_add_u32 s72, s71, 50176
    s_waitcnt vmcnt(19)
    buffer_load_dwordx4 v6, s[44:47], s72 offen nt lds
    s_mov_b32 m0, 158720
    s_add_u32 s72, s71, 53760
    s_waitcnt vmcnt(19)
    buffer_load_dwordx4 v6, s[44:47], s72 offen nt lds
    s_lshl_b32 s71, s59, 16
    s_lshl_b32 s72, s60, 7
    s_add_u32 s71, s71, s72
    v_lshl_add_u32 v5, v2, 13, v3
    s_mov_b32 m0, 20480
    s_add_u32 s72, s71, 0
    s_waitcnt vmcnt(19)
    buffer_load_dwordx4 v5, s[52:55], s72 offen offset:0 nt lds
    s_waitcnt vmcnt(19)
    buffer_load_dwordx4 v5, s[52:55], s72 offen offset:1024 nt lds
    s_waitcnt vmcnt(19)
    buffer_load_dwordx4 v5, s[52:55], s72 offen offset:2048 nt lds
    s_waitcnt vmcnt(19)
    buffer_load_dwordx4 v5, s[52:55], s72 offen offset:3072 nt lds
    ds_write_b32 v7, v24 offset:1024
    v_add_u32 v24, 8, v24
    s_mov_b32 m0, 24576
    s_add_u32 s72, s71, 4096
    s_waitcnt vmcnt(19)
    buffer_load_dwordx4 v5, s[52:55], s72 offen offset:0 nt lds
    s_waitcnt vmcnt(19)
    buffer_load_dwordx4 v5, s[52:55], s72 offen offset:1024 nt lds
    s_waitcnt vmcnt(19)
    buffer_load_dwordx4 v5, s[52:55], s72 offen offset:2048 nt lds
    s_waitcnt vmcnt(19)
    buffer_load_dwordx4 v5, s[52:55], s72 offen offset:3072 nt lds
    s_mov_b32 s40, s12
    s_mov_b32 s41, s13
    s_mov_b32 s42, 0x400000
    s_mov_b32 s43, 0x20000
    s_lshl_b32 s71, s57, 9
    s_lshr_b32 s72, s58, 4
    s_lshl_b32 s72, s72, 6
    s_add_u32 s71, s71, s72
    s_and_b32 s72, s58, 12
    s_add_u32 s71, s71, s72
    s_lshl_b32 s71, s71, 10
    s_and_b32 s72, s58, 3
    s_lshl_b32 s72, s72, 8
    s_add_u32 s71, s71, s72
    v_lshrrev_b32 v6, 4, v1
    v_mul_u32_u24 v6, 0x440, v6
    v_and_b32 v25, 0xf0, v4
    v_xor_b32 v6, v6, v25
    s_mov_b32 s77, s71
    s_lshl_b32 s70, s57, 24
    s_lshl_b32 s71, s58, 19
    s_add_u32 s70, s70, s71
    s_add_u32 s28, s6, s70
    s_addc_u32 s29, s7, 0
    s_mov_b32 s30, 0x80000
    s_mov_b32 s31, 0x20000
    s_add_u32 s32, s8, s70
    s_addc_u32 s33, s9, 0
    s_mov_b32 s34, 0x80000
    s_mov_b32 s35, 0x20000
    v_and_b32 v27, 0xf0, v4
    v_bfe_u32 v5, v1, 4, 1
    v_lshl_add_u32 v27, v5, 9, v27
    v_lshrrev_b32 v5, 5, v1
    v_lshl_add_u32 v27, v5, 13, v27
    v_lshrrev_b32 v5, 4, v1
    v_lshlrev_b32 v5, 6, v5
    v_xor_b32 v16, v27, v5
    v_and_b32 v5, 16, v1
    v_lshlrev_b32 v5, 1, v5
    v_xor_b32 v20, v27, v5
    v_xor_b32 v17, 16, v16
    v_xor_b32 v21, 64, v20
    v_xor_b32 v18, 32, v16
    v_xor_b32 v22, 128, v20
    v_xor_b32 v19, 48, v16
    v_xor_b32 v23, 192, v20
    s_mov_b32 s63, 0
    s_mov_b32 s85, 0
    s_mov_b32 s3, 0
    s_mov_b32 s74, 0
    s_mov_b32 s75, 40
    v_mov_b32 v25, 0
    v_subrev_u32 v26, 8, v24
L_tile:
    s_cmp_lg_u32 s63, 32
    s_cbranch_scc1 L_nosw
    s_mov_b64 s[28:29], s[32:33]
    s_mov_b32 s74, 0
    v_mov_b32 v16, v20
    v_mov_b32 v17, v21
    v_mov_b32 v18, v22
    v_mov_b32 v19, v23
L_nosw:
    s_sub_u32 s62, s63, 7
    s_cmp_lg_u32 s62, 0
    s_cbranch_scc1 L_nogup
    s_mov_b32 s84, 0
L_gup_1:
    ds_read_b32 v14, v7 offset:1028
    s_waitcnt lgkmcnt(0)
    v_readfirstlane_b32 s72, v14
    s_add_u32 s84, s84, 1
    s_cmp_ge_i32 s72, 1
    s_cbranch_scc1 L_gup_ok_2
    s_cmp_lt_u32 s84, 0x100000
    s_cbranch_scc1 L_gup_1
L_gup_ok_2:
L_nogup:
    s_cmp_ge_i32 s3, s62
    s_cbranch_scc1 L_free_ok_4
    s_mov_b32 s84, 0
L_free_3:
    ds_read_b64 v[14:15], v7 offset:1032
    s_waitcnt lgkmcnt(0)
    v_min_i32 v14, v14, v15
    s_nop 0
    v_readfirstlane_b32 s3, v14
    s_add_u32 s84, s84, 1
    s_cmp_ge_i32 s3, s62
    s_cbranch_scc1 L_free_ok_4
    s_cmp_lt_u32 s84, 0x100000
    s_cbranch_scc1 L_free_3
L_free_ok_4:
    s_add_u32 m0, s85, 28672
    s_waitcnt lgkmcnt(0)
    v_readfirstlane_b32 s76, v25
    ds_read_b32 v25, v7 offset:1068
    s_cmp_eq_u32 s76, 1
    s_cbranch_scc1 L_ver1
    s_cmp_eq_u32 s76, 2
    s_cbranch_scc1 L_ver2
    s_cmp_eq_u32 s76, 3
    s_cbranch_scc1 L_ver3
    s_cmp_eq_u32 s76, 4
    s_cbranch_scc1 L_ver4
L_ver0:
    s_sub_u32 s72, s75, 19
    v_mov_b32 v24, s72
L_vq0:
    s_waitcnt vmcnt(19)
    buffer_load_dwordx4 v16, s[28:31], s74 offen offset:0 nt lds
    v_max_i32 v26, v26, v24
    v_add_u32 v24, 4, v24
    ds_write_b32 v7, v26 offset:1024
    s_waitcnt vmcnt(19)
    buffer_load_dwordx4 v17, s[28:31], s74 offen offset:1024 nt lds
    s_waitcnt vmcnt(19)
    buffer_load_dwordx4 v18, s[28:31], s74 offen offset:2048 nt lds
    s_waitcnt vmcnt(19)
    buffer_load_dwordx4 v19, s[28:31], s74 offen offset:3072 nt lds
    s_addk_i32 m0, 0x1000
    s_addk_i32 s74, 256
    s_waitcnt vmcnt(19)
    buffer_load_dwordx4 v16, s[28:31], s74 offen offset:0 nt lds
    v_max_i32 v26, v26, v24
    v_add_u32 v24, 4, v24
    ds_write_b32 v7, v26 offset:1024
    s_waitcnt vmcnt(19)
    buffer_load_dwordx4 v17, s[28:31], s74 offen offset:1024 nt lds
    s_waitcnt vmcnt(19)
    buffer_load_dwordx4 v18, s[28:31], s74 offen offset:2048 nt lds
    s_waitcnt vmcnt(19)
    buffer_load_dwordx4 v19, s[28:31], s74 offen offset:3072 nt lds
    s_addk_i32 m0, 0x1000
    s_addk_i32 s74, 3840
    s_and_b32 s72, s74, 0x1fff
    s_cbranch_scc1 L_vq0
L_qend:
    s_add_u32 s75, s75, 16
    s_addk_i32 s74, 0x2000
    s_add_u32 s85, s85, 16384
    s_and_b32 s85, s85, 131071
    s_add_u32 s63, s63, 1
    s_cmp_lt_u32 s63, 64
    s_cbranch_scc1 L_tile
    s_cmp_ge_i32 s3, 57
    s_cbranch_scc1 L_freew_ok_6
    s_mov_b32 s84, 0
L_freew_5:
    ds_read_b64 v[14:15], v7 offset:1032
    s_waitcnt lgkmcnt(0)
    v_min_i32 v14, v14, v15
    s_nop 0
    v_readfirstlane_b32 s3, v14
    s_add_u32 s84, s84, 1
    s_cmp_ge_i32 s3, 57
    s_cbranch_scc1 L_freew_ok_6
    s_cmp_lt_u32 s84, 0x100000
    s_cbranch_scc1 L_freew_5
L_freew_ok_6:
    s_waitcnt vmcnt(24)
    v_max_i32 v26, 1040, v26
    ds_write_b32 v7, v26 offset:1024
    s_mov_b32 m0, 32768
    s_add_u32 s72, s77, 16384
    s_waitcnt vmcnt(19)
    buffer_load_dwordx4 v6, s[40:43], s72 offen nt lds
    s_mov_b32 m0, 33792
    s_add_u32 s72, s77, 147456
    s_waitcnt vmcnt(19)
    buffer_load_dwordx4 v6, s[40:43], s72 offen nt lds
    s_mov_b32 m0, 34816
    s_add_u32 s72, s77, 278528
    s_waitcnt vmcnt(19)
    buffer_load_dwordx4 v6, s[40:43], s72 offen nt lds
    s_mov_b32 m0, 35840
    s_add_u32 s72, s77, 409600
    s_waitcnt vmcnt(19)
    v_max_i32 v26, 1048, v26
    ds_write_b32 v7, v26 offset:1024
    buffer_load_dwordx4 v6, s[40:43], s72 offen nt lds
    s_mov_b32 m0, 36864
    s_add_u32 s72, s77, 32768
    s_waitcnt vmcnt(19)
    buffer_load_dwordx4 v6, s[40:43], s72 offen nt lds
    s_mov_b32 m0, 37888
    s_add_u32 s72, s77, 163840
    s_waitcnt vmcnt(19)
    buffer_load_dwordx4 v6, s[40:43], s72 offen nt lds
    s_mov_b32 m0, 38912
    s_add_u32 s72, s77, 294912
    s_waitcnt vmcnt(19)
    buffer_load_dwordx4 v6, s[40:43], s72 offen nt lds
    s_mov_b32 m0, 39936
    s_add_u32 s72, s77, 425984
    s_waitcnt vmcnt(19)
    buffer_load_dwordx4 v6, s[40:43], s72 offen nt lds
    s_mov_b32 m0, 28672
    s_add_u32 s72, s77, 0
    s_waitcnt vmcnt(19)
    buffer_load_dwordx4 v6, s[40:43], s72 offen nt lds
    s_mov_b32 m0, 29696
    s_add_u32 s72, s77, 131072
    s_waitcnt vmcnt(19)
    buffer_load_dwordx4 v6, s[40:43], s72 offen nt lds
    s_mov_b32 m0, 30720
    s_add_u32 s72, s77, 262144
    s_waitcnt vmcnt(19)
    buffer_load_dwordx4 v6, s[40:43], s72 offen nt lds
    s_mov_b32 m0, 31744
    s_add_u32 s72, s77, 393216
    s_waitcnt vmcnt(19)
    v_max_i32 v26, 1056, v26
    ds_write_b32 v7, v26 offset:1024
    buffer_load_dwordx4 v6, s[40:43], s72 offen nt lds
    s_mov_b32 m0, 40960
    s_add_u32 s72, s77, 49152
    s_waitcnt vmcnt(19)
    buffer_load_dwordx4 v6, s[40:43], s72 offen nt lds
    s_mov_b32 m0, 41984
    s_add_u32 s72, s77, 180224
    s_waitcnt vmcnt(19)
    buffer_load_dwordx4 v6, s[40:43], s72 offen nt lds
    s_mov_b32 m0, 43008
    s_add_u32 s72, s77, 311296
    s_waitcnt vmcnt(19)
    buffer_load_dwordx4 v6, s[40:43], s72 offen nt lds
    s_mov_b32 m0, 44032
    s_add_u32 s72, s77, 442368
    s_waitcnt vmcnt(19)
    buffer_load_dwordx4 v6, s[40:43], s72 offen nt lds
    v_max_i32 v26, 1064, v26
    s_waitcnt vmcnt(16)
    ds_write_b32 v7, v26 offset:1024
    v_max_i32 v26, 1068, v26
    s_waitcnt vmcnt(12)
    ds_write_b32 v7, v26 offset:1024
    v_max_i32 v26, 1072, v26
    s_waitcnt vmcnt(8)
    ds_write_b32 v7, v26 offset:1024
    v_max_i32 v26, 1076, v26
    s_waitcnt vmcnt(4)
    ds_write_b32 v7, v26 offset:1024
    v_max_i32 v26, 1080, v26
    s_waitcnt vmcnt(0)
    ds_write_b32 v7, v26 offset:1024
    s_branch L_fin
L_ver1:
    s_sub_u32 s72, s75, 20
    v_mov_b32 v24, s72
L_vq1:
    s_waitcnt vmcnt(20)
    buffer_load_dwordx4 v16, s[28:31], s74 offen offset:0 nt lds
    v_max_i32 v26, v26, v24
    v_add_u32 v24, 4, v24
    ds_write_b32 v7, v26 offset:1024
    s_waitcnt vmcnt(20)
    buffer_load_dwordx4 v17, s[28:31], s74 offen offset:1024 nt lds
    s_waitcnt vmcnt(20)
    buffer_load_dwordx4 v18, s[28:31], s74 offen offset:2048 nt lds
    s_waitcnt vmcnt(20)
    buffer_load_dwordx4 v19, s[28:31], s74 offen offset:3072 nt lds
    s_addk_i32 m0, 0x1000
    s_addk_i32 s74, 256
    s_waitcnt vmcnt(20)
    buffer_load_dwordx4 v16, s[28:31], s74 offen offset:0 nt lds
    v_max_i32 v26, v26, v24
    v_add_u32 v24, 4, v24
    ds_write_b32 v7, v26 offset:1024
    s_waitcnt vmcnt(20)
    buffer_load_dwordx4 v17, s[28:31], s74 offen offset:1024 nt lds
    s_waitcnt vmcnt(20)
    buffer_load_dwordx4 v18, s[28:31], s74 offen offset:2048 nt lds
    s_waitcnt vmcnt(20)
    buffer_load_dwordx4 v19, s[28:31], s74 offen offset:3072 nt lds
    s_addk_i32 m0, 0x1000
    s_addk_i32 s74, 3840
    s_and_b32 s72, s74, 0x1fff
    s_cbranch_scc1 L_vq1
    s_branch L_qend
L_ver2:
    s_sub_u32 s72, s75, 21
    v_mov_b32 v24, s72
L_vq2:
    s_waitcnt vmcnt(21)
    buffer_load_dwordx4 v16, s[28:31], s74 offen offset:0 nt lds
    v_max_i32 v26, v26, v24
    v_add_u32 v24, 4, v24
    ds_write_b32 v7, v26 offset:1024
    s_waitcnt vmcnt(21)
    buffer_load_dwordx4 v17, s[28:31], s74 offen offset:1024 nt lds
    s_waitcnt vmcnt(21)
    buffer_load_dwordx4 v18, s[28:31], s74 offen offset:2048 nt lds
    s_waitcnt vmcnt(21)
    buffer_load_dwordx4 v19, s[28:31], s74 offen offset:3072 nt lds
    s_addk_i32 m0, 0x1000
    s_addk_i32 s74, 256
    s_waitcnt vmcnt(21)
    buffer_load_dwordx4 v16, s[28:31], s74 offen offset:0 nt lds
    v_max_i32 v26, v26, v24
    v_add_u32 v24, 4, v24
    ds_write_b32 v7, v26 offset:1024
    s_waitcnt vmcnt(21)
    buffer_load_dwordx4 v17, s[28:31], s74 offen offset:1024 nt lds
    s_waitcnt vmcnt(21)
    buffer_load_dwordx4 v18, s[28:31], s74 offen offset:2048 nt lds
    s_waitcnt vmcnt(21)
    buffer_load_dwordx4 v19, s[28:31], s74 offen offset:3072 nt lds
    s_addk_i32 m0, 0x1000
    s_addk_i32 s74, 3840
    s_and_b32 s72, s74, 0x1fff
    s_cbranch_scc1 L_vq2
    s_branch L_qend
L_ver3:
    s_sub_u32 s72, s75, 23
    v_mov_b32 v24, s72
L_vq3:
    s_waitcnt vmcnt(23)
    buffer_load_dwordx4 v16, s[28:31], s74 offen offset:0 nt lds
    v_max_i32 v26, v26, v24
    v_add_u32 v24, 4, v24
    ds_write_b32 v7, v26 offset:1024
    s_waitcnt vmcnt(23)
    buffer_load_dwordx4 v17, s[28:31], s74 offen offset:1024 nt lds
    s_waitcnt vmcnt(23)
    buffer_load_dwordx4 v18, s[28:31], s74 offen offset:2048 nt lds
    s_waitcnt vmcnt(23)
    buffer_load_dwordx4 v19, s[28:31], s74 offen offset:3072 nt lds
    s_addk_i32 m0, 0x1000
    s_addk_i32 s74, 256
    s_waitcnt vmcnt(23)
    buffer_load_dwordx4 v16, s[28:31], s74 offen offset:0 nt lds
    v_max_i32 v26, v26, v24
    v_add_u32 v24, 4, v24
    ds_write_b32 v7, v26 offset:1024
    s_waitcnt vmcnt(23)
    buffer_load_dwordx4 v17, s[28:31], s74 offen offset:1024 nt lds
    s_waitcnt vmcnt(23)
    buffer_load_dwordx4 v18, s[28:31], s74 offen offset:2048 nt lds
    s_waitcnt vmcnt(23)
    buffer_load_dwordx4 v19, s[28:31], s74 offen offset:3072 nt lds
    s_addk_i32 m0, 0x1000
    s_addk_i32 s74, 3840
    s_and_b32 s72, s74, 0x1fff
    s_cbranch_scc1 L_vq3
    s_branch L_qend
L_ver4:
    s_sub_u32 s72, s75, 26
    v_mov_b32 v24, s72
L_vq4:
    s_waitcnt vmcnt(26)
    buffer_load_dwordx4 v16, s[28:31], s74 offen offset:0 nt lds
    v_max_i32 v26, v26, v24
    v_add_u32 v24, 4, v24
    ds_write_b32 v7, v26 offset:1024
    s_waitcnt vmcnt(26)
    buffer_load_dwordx4 v17, s[28:31], s74 offen offset:1024 nt lds
    s_waitcnt vmcnt(26)
    buffer_load_dwordx4 v18, s[28:31], s74 offen offset:2048 nt lds
    s_waitcnt vmcnt(26)
    buffer_load_dwordx4 v19, s[28:31], s74 offen offset:3072 nt lds
    s_addk_i32 m0, 0x1000
    s_addk_i32 s74, 256
    s_waitcnt vmcnt(26)
    buffer_load_dwordx4 v16, s[28:31], s74 offen offset:0 nt lds
    v_max_i32 v26, v26, v24
    v_add_u32 v24, 4, v24
    ds_write_b32 v7, v26 offset:1024
    s_waitcnt vmcnt(26)
    buffer_load_dwordx4 v17, s[28:31], s74 offen offset:1024 nt lds
    s_waitcnt vmcnt(26)
    buffer_load_dwordx4 v18, s[28:31], s74 offen offset:2048 nt lds
    s_waitcnt vmcnt(26)
    buffer_load_dwordx4 v19, s[28:31], s74 offen offset:3072 nt lds
    s_addk_i32 m0, 0x1000
    s_addk_i32 s74, 3840
    s_and_b32 s72, s74, 0x1fff
    s_cbranch_scc1 L_vq4
    s_branch L_qend
L_pace:
    s_mov_b32 s82, 0
    v_bfe_u32 v5, v1, 2, 3
    v_lshlrev_b32 v5, 7, v5
    v_lshrrev_b32 v6, 5, v1
    v_lshl_add_u32 v5, v6, 17, v5
    v_and_b32 v215, 3, v1
    v_lshl_add_u32 v214, v215, 4, v5
    v_lshl_add_u32 v215, v215, 1, v6
    v_lshlrev_b32 v215, 2, v215
    v_bfe_u32 v5, v1, 2, 2
    v_mul_u32_u24 v5, 0x140, v5
    v_lshrrev_b32 v6, 4, v1
    v_lshlrev_b32 v6, 5, v6
    v_xor_b32 v5, v5, v6
    v_and_b32 v6, 3, v1
    v_lshl_add_u32 v5, v6, 3, v5
    s_lshl_b32 s72, s82, 12
    v_add_u32 v212, s72, v5
    v_xor_b32 v213, 0x80, v212
    s_and_b32 s72, s58, 28
    s_add_u32 s72, s72, s82
    s_lshl_b32 s72, s72, 11
    s_add_u32 s24, s0, s72
    s_lshl_b32 s72, s82, 9
    s_add_u32 s72, s72, 2048
    v_lshl_add_u32 v208, v1, 2, s72
    v_lshlrev_b32 v209, 3, v1
    v_and_b32 v5, 15, v1
    v_lshlrev_b32 v5, 3, v5
    v_lshrrev_b32 v6, 4, v1
    v_lshl_add_u32 v210, v6, 10, v5
    s_and_b32 s25, s58, 3
    s_lshl_b32 s25, s25, 12
    s_add_u32 s25, s25, s0
    s_lshr_b32 s72, s58, 2
    s_lshl_b32 s72, s72, 7
    s_add_u32 s25, s25, s72
    s_add_u32 s25, s25, 86016
    s_cmp_lg_u32 s57, 0
    s_cbranch_scc1 L_noh2
    buffer_load_dword v20, v210, s[36:39], s25 offen sc1
L_noh2:
    s_waitcnt lgkmcnt(0)
    s_add_u32 s64, s64, 0x9E3779B1
    v_and_b32 v5, 1, v1
    v_lshlrev_b32 v5, 4, v5
    v_lshrrev_b32 v5, v5, s64
    v_bfe_u32 v8, v5, 0, 4
    v_bfe_u32 v9, v5, 4, 4
    v_bfe_u32 v10, v5, 8, 4
    v_bfe_u32 v11, v5, 12, 4
    v_and_b32 v5, 3, v1
    v_lshlrev_b32 v5, 3, v5
    v_lshrrev_b32 v5, v5, s64
    v_bfe_u32 v12, v5, 0, 4
    v_bfe_u32 v13, v5, 4, 4
    v_mov_b32 v14, 1
    ds_write_b32 v7, v14 offset:1072
    s_getreg_b32 s79, hwreg(HW_REG_XCC_ID, 0, 1)
    s_cmp_eq_u32 s79, 0
    s_cselect_b32 s79, 224, 0
    s_add_u32 s79, s79, 192
    s_cmp_eq_u32 s57, 0
    s_cselect_b32 s70, -64, 0
    s_add_u32 s79, s79, s70
    s_mov_b32 s84, 0
L_qhp_7:
    ds_read_b32 v14, v7 offset:1040
    s_waitcnt lgkmcnt(0)
    v_readfirstlane_b32 s14, v14
    s_add_u32 s84, s84, 1
    s_cmp_ge_i32 s14, 1
    s_cbranch_scc1 L_qhp_ok_8
    s_sleep 8
    s_cmp_lt_u32 s84, 0x100000
    s_cbranch_scc1 L_qhp_7
L_qhp_ok_8:
    s_cmp_lg_u32 s14, 2
    s_cbranch_scc1 L_late
    v_lshlrev_b32 v5, 2, v1
    s_add_u32 s77, s0, 82944
    s_lshl2_add_u32 s78, s58, s77
    s_mov_b32 s74, 0
    s_mov_b32 s63, 0
    s_and_b32 s73, s64, 0xfffff800
L_pl:
    s_mov_b32 s75, s74
    ds_read_b32 v16, v7 offset:1024
    s_waitcnt lgkmcnt(0)
    v_readfirstlane_b32 s74, v16
    s_add_u32 s63, s63, 1
    s_cmp_gt_u32 s63, 0x10000
    s_cbranch_scc1 L_late
    v_or_b32 v16, s73, v16
    s_mov_b64 exec, 1
    buffer_store_dword v16, v7, s[36:39], s78 offen
    s_mov_b64 exec, -1
    s_cmp_ge_u32 s74, 1016
    s_cbranch_scc1 L_late
    s_mov_b32 exec_hi, 0
    buffer_load_dword v17, v5, s[36:39], s77 offen sc1
    s_waitcnt vmcnt(0)
    v_xor_b32 v19, s73, v17
    v_cmp_lt_u32 vcc, 0x7ff, v19
    s_nop 1
    v_add_u32 v19, v19, v19 row_ror:8
    s_nop 1
    v_add_u32 v19, v19, v19 row_ror:4
    s_nop 1
    v_add_u32 v19, v19, v19 row_ror:2
    s_nop 1
    v_add_u32 v19, v19, v19 row_ror:1
    s_cbranch_vccnz L_pnext
    v_readlane_b32 s76, v19, 0
    v_readlane_b32 s70, v19, 16
    s_cmp_eq_u32 s75, 0
    s_cbranch_scc1 L_pnext
    s_add_u32 s76, s76, s70
    s_add_u32 s70, s74, s75
    s_lshl_b32 s70, s70, 4
    s_sub_u32 s70, s76, s70
    s_add_u32 s70, s70, s79
    s_ashr_i32 s70, s70, 8
    s_max_i32 s70, s70, 0
    s_min_i32 s70, s70, 4
    v_mov_b32 v16, s70
    ds_write_b32 v7, v16 offset:1068
L_pnext:
    s_mov_b64 exec, -1
    s_sleep 8
    s_branch L_pl
L_notloader:
    s_load_dword s64, s[26:27], 126976
    s_mov_b32 s15, 0x40000
    s_mov_b32 s14, 1
    s_lshl_b32 s0, s57, 17
    s_mov_b32 s36, s26
    s_mov_b32 s37, s27
    s_mov_b32 s38, 0x20000000
    s_mov_b32 s39, 0x20000
    s_mov_b32 s82, s56
    s_cmp_eq_u32 s56, 4
    s_cbranch_scc1 L_pace
    s_cmp_eq_u32 s56, 3
    s_cbranch_scc1 L_help
    s_sub_u32 s61, s56, 1
    s_cmp_eq_u32 s56, 2
    s_cbranch_scc1 L_w2
    s_waitcnt lgkmcnt(0)
    s_add_u32 s64, s64, 0x9E3779B1
    v_and_b32 v5, 1, v1
    v_lshlrev_b32 v5, 4, v5
    v_lshrrev_b32 v5, v5, s64
    v_bfe_u32 v8, v5, 0, 4
    v_bfe_u32 v9, v5, 4, 4
    v_bfe_u32 v10, v5, 8, 4
    v_bfe_u32 v11, v5, 12, 4
    v_and_b32 v5, 3, v1
    v_lshlrev_b32 v5, 3, v5
    v_lshrrev_b32 v5, v5, s64
    v_bfe_u32 v12, v5, 0, 4
    v_bfe_u32 v13, v5, 4, 4
    s_branch L_qwait
L_w2:
    s_lshr_b32 s73, s2, 6
    s_waitcnt vmcnt(0)
    v_lshlrev_b32 v32, 16, v16
    v_and_b32 v33, s69, v16
    v_lshlrev_b32 v34, 16, v17
    v_and_b32 v35, s69, v17
    v_lshlrev_b32 v36, 16, v18
    v_and_b32 v37, s69, v18
    v_lshlrev_b32 v38, 16, v19
    v_and_b32 v39, s69, v19
    v_add_f32 v28, v32, v33
    v_add_f32 v28, v28, v34
    v_add_f32 v28, v28, v35
    v_add_f32 v28, v28, v36
    v_add_f32 v28, v28, v37
    v_add_f32 v28, v28, v38
    v_add_f32 v28, v28, v39
    s_nop 1
    v_add_f32 v28, v28, v28 row_ror:8
    s_nop 1
    v_add_f32 v28, v28, v28 row_ror:4
    s_nop 1
    v_add_f32 v28, v28, v28 row_ror:2
    s_nop 1
    v_add_f32 v28, v28, v28 row_ror:1
    v_mov_b32 v14, v28
    s_nop 1
    v_permlane16_swap_b32 v28, v14
    s_nop 1
    v_add_f32 v28, v28, v14
    v_mov_b32 v14, v28
    s_nop 1
    v_permlane32_swap_b32 v28, v14
    s_nop 1
    v_add_f32 v28, v28, v14
    v_mul_f32 v28, 0x3b000000, v28
    v_sub_f32 v40, v32, v28
    v_sub_f32 v41, v33, v28
    v_sub_f32 v42, v34, v28
    v_sub_f32 v43, v35, v28
    v_sub_f32 v44, v36, v28
    v_sub_f32 v45, v37, v28
    v_sub_f32 v46, v38, v28
    v_sub_f32 v47, v39, v28
    v_mul_f32 v29, v40, v40
    v_fmac_f32 v29, v41, v41
    v_fmac_f32 v29, v42, v42
    v_fmac_f32 v29, v43, v43
    v_fmac_f32 v29, v44, v44
    v_fmac_f32 v29, v45, v45
    v_fmac_f32 v29, v46, v46
    v_fmac_f32 v29, v47, v47
    s_nop 1
    v_add_f32 v29, v29, v29 row_ror:8
    s_nop 1
    v_add_f32 v29, v29, v29 row_ror:4
    s_nop 1
    v_add_f32 v29, v29, v29 row_ror:2
    s_nop 1
    v_add_f32 v29, v29, v29 row_ror:1
    v_mov_b32 v14, v29
    s_nop 1
    v_permlane16_swap_b32 v29, v14
    s_nop 1
    v_add_f32 v29, v29, v14
    v_mov_b32 v14, v29
    s_nop 1
    v_permlane32_swap_b32 v29, v14
    s_nop 1
    v_add_f32 v29, v29, v14
    v_mul_f32 v29, 0x3b000000, v29
    v_cvt_pk_bf16_f32 v28, v28, v28
    v_and_b32 v28, 0xffff0000, v28
    v_cvt_pk_bf16_f32 v29, v29, v29
    v_and_b32 v29, 0xffff0000, v29
    v_add_f32 v29, 0x3727c5ac, v29
    v_cvt_pk_bf16_f32 v29, v29, v29
    v_and_b32 v29, 0xffff0000, v29
    v_sqrt_f32 v29, v29
    s_nop 0
    v_cvt_pk_bf16_f32 v29, v29, v29
    v_and_b32 v29, 0xffff0000, v29
    v_rcp_f32 v29, v29
    v_lshlrev_b32 v32, 16, v16
    v_and_b32 v33, s69, v16
    v_lshlrev_b32 v34, 16, v17
    v_and_b32 v35, s69, v17
    v_lshlrev_b32 v36, 16, v18
    v_and_b32 v37, s69, v18
    v_lshlrev_b32 v38, 16, v19
    v_and_b32 v39, s69, v19
    v_sub_f32 v32, v32, v28
    v_sub_f32 v33, v33, v28
    v_sub_f32 v34, v34, v28
    v_sub_f32 v35, v35, v28
    v_sub_f32 v36, v36, v28
    v_sub_f32 v37, v37, v28
    v_sub_f32 v38, v38, v28
    v_sub_f32 v39, v39, v28
    v_cvt_pk_bf16_f32 v16, v32, v33
    v_cvt_pk_bf16_f32 v17, v34, v35
    v_cvt_pk_bf16_f32 v18, v36, v37
    v_cvt_pk_bf16_f32 v19, v38, v39
    v_lshlrev_b32 v32, 16, v16
    v_and_b32 v33, s69, v16
    v_lshlrev_b32 v34, 16, v17
    v_and_b32 v35, s69, v17
    v_lshlrev_b32 v36, 16, v18
    v_and_b32 v37, s69, v18
    v_lshlrev_b32 v38, 16, v19
    v_and_b32 v39, s69, v19
    v_mul_f32 v32, v32, v29
    v_mul_f32 v33, v33, v29
    v_mul_f32 v34, v34, v29
    v_mul_f32 v35, v35, v29
    v_mul_f32 v36, v36, v29
    v_mul_f32 v37, v37, v29
    v_mul_f32 v38, v38, v29
    v_mul_f32 v39, v39, v29
    v_cvt_pk_bf16_f32 v16, v32, v33
    v_cvt_pk_bf16_f32 v17, v34, v35
    v_cvt_pk_bf16_f32 v18, v36, v37
    v_cvt_pk_bf16_f32 v19, v38, v39
    ds_write_b128 v4, v[16:19] offset:2048
    v_mov_b32 v14, 1
    ds_write_b32 v7, v14 offset:1044
    s_waitcnt lgkmcnt(0)
    s_add_u32 s64, s64, 0x9E3779B1
    v_and_b32 v5, 1, v1
    v_lshlrev_b32 v5, 4, v5
    v_lshrrev_b32 v5, v5, s64
    v_bfe_u32 v8, v5, 0, 4
    v_bfe_u32 v9, v5, 4, 4
    v_bfe_u32 v10, v5, 8, 4
    v_bfe_u32 v11, v5, 12, 4
    v_and_b32 v5, 3, v1
    v_lshlrev_b32 v5, 3, v5
    v_lshrrev_b32 v5, v5, s64
    v_bfe_u32 v12, v5, 0, 4
    v_bfe_u32 v13, v5, 4, 4
    s_lshl_b32 s72, s73, 8
    v_lshl_add_u32 v5, v2, 5, s72
    ds_read_b128 v[20:23], v5 offset:2048
    ds_read_b128 v[24:27], v5 offset:2064
    v_add_u32 v6, 4096, v4
    s_mov_b32 s84, 0
L_wsl_9:
    ds_read_b32 v14, v7 offset:1024
    s_waitcnt lgkmcnt(0)
    v_readfirstlane_b32 s3, v14
    s_add_u32 s84, s84, 1
    s_cmp_ge_i32 s3, 8
    s_cbranch_scc1 L_wsl_ok_10
    s_sleep 1
    s_cmp_lt_u32 s84, 0x100000
    s_cbranch_scc1 L_wsl_9
L_wsl_ok_10:
    ds_read_b128 v[64:67], v6 offset:0
    ds_read_b128 v[68:71], v6 offset:1024
    ds_read_b128 v[72:75], v6 offset:2048
    ds_read_b128 v[76:79], v6 offset:3072
    ds_read_b128 v[80:83], v6 offset:4096
    ds_read_b128 v[84:87], v6 offset:5120
    ds_read_b128 v[88:91], v6 offset:6144
    ds_read_b128 v[92:95], v6 offset:7168
    s_waitcnt lgkmcnt(0)
    v_perm_b32 v40, v68, v64, s65
    v_perm_b32 v41, v68, v64, s66
    v_perm_b32 v42, v69, v65, s65
    v_perm_b32 v43, v69, v65, s66
    v_perm_b32 v44, v70, v66, s65
    v_perm_b32 v45, v70, v66, s66
    v_perm_b32 v46, v71, v67, s65
    v_perm_b32 v47, v71, v67, s66
    v_dot2_f32_bf16 v32, v20, v40, 0
    v_dot2_f32_bf16 v33, v20, v41, 0
    v_dot2_f32_bf16 v34, v20, v42, 0
    v_dot2_f32_bf16 v35, v20, v43, 0
    v_dot2_f32_bf16 v36, v20, v44, 0
    v_dot2_f32_bf16 v37, v20, v45, 0
    v_dot2_f32_bf16 v38, v20, v46, 0
    v_dot2_f32_bf16 v39, v20, v47, 0
    v_perm_b32 v40, v76, v72, s65
    v_perm_b32 v41, v76, v72, s66
    v_perm_b32 v42, v77, v73, s65
    v_perm_b32 v43, v77, v73, s66
    v_perm_b32 v44, v78, v74, s65
    v_perm_b32 v45, v78, v74, s66
    v_perm_b32 v46, v79, v75, s65
    v_perm_b32 v47, v79, v75, s66
    v_dot2_f32_bf16 v32, v21, v40, v32
    v_dot2_f32_bf16 v33, v21, v41, v33
    v_dot2_f32_bf16 v34, v21, v42, v34
    v_dot2_f32_bf16 v35, v21, v43, v35
    v_dot2_f32_bf16 v36, v21, v44, v36
    v_dot2_f32_bf16 v37, v21, v45, v37
    v_dot2_f32_bf16 v38, v21, v46, v38
    v_dot2_f32_bf16 v39, v21, v47, v39
    v_perm_b32 v40, v84, v80, s65
    v_perm_b32 v41, v84, v80, s66
    v_perm_b32 v42, v85, v81, s65
    v_perm_b32 v43, v85, v81, s66
    v_perm_b32 v44, v86, v82, s65
    v_perm_b32 v45, v86, v82, s66
    v_perm_b32 v46, v87, v83, s65
    v_perm_b32 v47, v87, v83, s66
    v_dot2_f32_bf16 v32, v22, v40, v32
    v_dot2_f32_bf16 v33, v22, v41, v33
    v_dot2_f32_bf16 v34, v22, v42, v34
    v_dot2_f32_bf16 v35, v22, v43, v35
    v_dot2_f32_bf16 v36, v22, v44, v36
    v_dot2_f32_bf16 v37, v22, v45, v37
    v_dot2_f32_bf16 v38, v22, v46, v38
    v_dot2_f32_bf16 v39, v22, v47, v39
    v_perm_b32 v40, v92, v88, s65
    v_perm_b32 v41, v92, v88, s66
    v_perm_b32 v42, v93, v89, s65
    v_perm_b32 v43, v93, v89, s66
    v_perm_b32 v44, v94, v90, s65
    v_perm_b32 v45, v94, v90, s66
    v_perm_b32 v46, v95, v91, s65
    v_perm_b32 v47, v95, v91, s66
    v_dot2_f32_bf16 v32, v23, v40, v32
    v_dot2_f32_bf16 v33, v23, v41, v33
    v_dot2_f32_bf16 v34, v23, v42, v34
    v_dot2_f32_bf16 v35, v23, v43, v35
    v_dot2_f32_bf16 v36, v23, v44, v36
    v_dot2_f32_bf16 v37, v23, v45, v37
    v_dot2_f32_bf16 v38, v23, v46, v38
    v_dot2_f32_bf16 v39, v23, v47, v39
    s_nop 2
    s_mov_b32 s84, 0
L_wsl_11:
    ds_read_b32 v14, v7 offset:1024
    s_waitcnt lgkmcnt(0)
    v_readfirstlane_b32 s3, v14
    s_add_u32 s84, s84, 1
    s_cmp_ge_i32 s3, 16
    s_cbranch_scc1 L_wsl_ok_12
    s_sleep 1
    s_cmp_lt_u32 s84, 0x100000
    s_cbranch_scc1 L_wsl_11
L_wsl_ok_12:
    ds_read_b128 v[64:67], v6 offset:8192
    ds_read_b128 v[68:71], v6 offset:9216
    ds_read_b128 v[72:75], v6 offset:10240
    ds_read_b128 v[76:79], v6 offset:11264
    ds_read_b128 v[80:83], v6 offset:12288
    ds_read_b128 v[84:87], v6 offset:13312
    ds_read_b128 v[88:91], v6 offset:14336
    ds_read_b128 v[92:95], v6 offset:15360
    s_waitcnt lgkmcnt(0)
    v_perm_b32 v40, v68, v64, s65
    v_perm_b32 v41, v68, v64, s66
    v_perm_b32 v42, v69, v65, s65
    v_perm_b32 v43, v69, v65, s66
    v_perm_b32 v44, v70, v66, s65
    v_perm_b32 v45, v70, v66, s66
    v_perm_b32 v46, v71, v67, s65
    v_perm_b32 v47, v71, v67, s66
    v_dot2_f32_bf16 v32, v24, v40, v32
    v_dot2_f32_bf16 v33, v24, v41, v33
    v_dot2_f32_bf16 v34, v24, v42, v34
    v_dot2_f32_bf16 v35, v24, v43, v35
    v_dot2_f32_bf16 v36, v24, v44, v36
    v_dot2_f32_bf16 v37, v24, v45, v37
    v_dot2_f32_bf16 v38, v24, v46, v38
    v_dot2_f32_bf16 v39, v24, v47, v39
    v_perm_b32 v40, v76, v72, s65
    v_perm_b32 v41, v76, v72, s66
    v_perm_b32 v42, v77, v73, s65
    v_perm_b32 v43, v77, v73, s66
    v_perm_b32 v44, v78, v74, s65
    v_perm_b32 v45, v78, v74, s66
    v_perm_b32 v46, v79, v75, s65
    v_perm_b32 v47, v79, v75, s66
    v_dot2_f32_bf16 v32, v25, v40, v32
    v_dot2_f32_bf16 v33, v25, v41, v33
    v_dot2_f32_bf16 v34, v25, v42, v34
    v_dot2_f32_bf16 v35, v25, v43, v35
    v_dot2_f32_bf16 v36, v25, v44, v36
    v_dot2_f32_bf16 v37, v25, v45, v37
    v_dot2_f32_bf16 v38, v25, v46, v38
    v_dot2_f32_bf16 v39, v25, v47, v39
    v_perm_b32 v40, v84, v80, s65
    v_perm_b32 v41, v84, v80, s66
    v_perm_b32 v42, v85, v81, s65
    v_perm_b32 v43, v85, v81, s66
    v_perm_b32 v44, v86, v82, s65
    v_perm_b32 v45, v86, v82, s66
    v_perm_b32 v46, v87, v83, s65
    v_perm_b32 v47, v87, v83, s66
    v_dot2_f32_bf16 v32, v26, v40, v32
    v_dot2_f32_bf16 v33, v26, v41, v33
    v_dot2_f32_bf16 v34, v26, v42, v34
    v_dot2_f32_bf16 v35, v26, v43, v35
    v_dot2_f32_bf16 v36, v26, v44, v36
    v_dot2_f32_bf16 v37, v26, v45, v37
    v_dot2_f32_bf16 v38, v26, v46, v38
    v_dot2_f32_bf16 v39, v26, v47, v39
    v_perm_b32 v40, v92, v88, s65
    v_perm_b32 v41, v92, v88, s66
    v_perm_b32 v42, v93, v89, s65
    v_perm_b32 v43, v93, v89, s66
    v_perm_b32 v44, v94, v90, s65
    v_perm_b32 v45, v94, v90, s66
    v_perm_b32 v46, v95, v91, s65
    v_perm_b32 v47, v95, v91, s66
    v_dot2_f32_bf16 v32, v27, v40, v32
    v_dot2_f32_bf16 v33, v27, v41, v33
    v_dot2_f32_bf16 v34, v27, v42, v34
    v_dot2_f32_bf16 v35, v27, v43, v35
    v_dot2_f32_bf16 v36, v27, v44, v36
    v_dot2_f32_bf16 v37, v27, v45, v37
    v_dot2_f32_bf16 v38, v27, v46, v38
    v_dot2_f32_bf16 v39, v27, v47, v39
    s_nop 2
    s_nop 1
    v_permlane32_swap_b32 v32, v36
    v_permlane32_swap_b32 v33, v37
    v_permlane32_swap_b32 v34, v38
    v_permlane32_swap_b32 v35, v39
    s_nop 1
    v_add_f32 v32, v32, v36
    v_add_f32 v33, v33, v37
    v_add_f32 v34, v34, v38
    v_add_f32 v35, v35, v39
    s_nop 1
    v_permlane16_swap_b32 v32, v34
    v_permlane16_swap_b32 v33, v35
    s_nop 1
    v_add_f32 v32, v32, v34
    v_add_f32 v33, v33, v35
    s_nop 0
    v_add_f32 v32, v32, v32 row_ror:8
    v_add_f32 v33, v33, v33 row_ror:8
    s_nop 0
    v_lshrrev_b32 v6, 4, v1
    v_lshlrev_b32 v6, 6, v6
    v_lshrrev_b32 v5, 1, v3
    v_add_u32 v6, v6, v5
    s_getreg_b32 s78, hwreg(HW_REG_XCC_ID, 0, 4)
    v_and_or_b32 v34, v32, -16, v12
    v_and_or_b32 v35, v33, -16, v13
    v_xor_b32 v32, s78, v34
    v_xor_b32 v33, s78, v35
    s_add_u32 s74, s0, 65536
    s_lshl_b32 s72, s58, 8
    s_add_u32 s71, s74, s72
    s_mov_b32 exec_lo, 0x00ff00ff
    s_mov_b32 exec_hi, 0x00ff00ff
    buffer_store_dwordx2 v[32:33], v6, s[36:39], s71 offen
    s_mov_b64 exec, -1
    v_xor_b32 v36, s78, v8
    v_xor_b32 v37, s78, v9
    v_xor_b32 v38, s78, v10
    v_xor_b32 v39, s78, v11
    s_add_u32 s75, s74, 4096
    s_mov_b32 s14, 2
    s_mov_b32 s84, 0
L_qgate_13:
    ds_read_b32 v14, v7 offset:1024
    s_waitcnt lgkmcnt(0)
    v_readfirstlane_b32 s3, v14
    s_add_u32 s84, s84, 1
    s_cmp_ge_i32 s3, 64
    s_cbranch_scc1 L_qgate_ok_14
    s_sleep 2
    s_cmp_lt_u32 s84, 0x100000
    s_cbranch_scc1 L_qgate_13
L_qgate_ok_14:
    s_mov_b32 s84, 0
L_qpoll:
    buffer_load_dwordx4 v[64:67], v4, s[36:39], s74 offen offset:0 sc1
    buffer_load_dwordx4 v[68:71], v4, s[36:39], s74 offen offset:1024 sc1
    buffer_load_dwordx4 v[72:75], v4, s[36:39], s74 offen offset:2048 sc1
    buffer_load_dwordx4 v[76:79], v4, s[36:39], s74 offen offset:3072 sc1
    buffer_load_dwordx4 v[80:83], v4, s[36:39], s75 offen offset:0 sc1
    buffer_load_dwordx4 v[84:87], v4, s[36:39], s75 offen offset:1024 sc1
    buffer_load_dwordx4 v[88:91], v4, s[36:39], s75 offen offset:2048 sc1
    buffer_load_dwordx4 v[92:95], v4, s[36:39], s75 offen offset:3072 sc1
    s_waitcnt vmcnt(0)
    v_xor_b32 v64, v36, v64
    v_xor_b32 v65, v37, v65
    v_xor_b32 v66, v38, v66
    v_xor_b32 v67, v39, v67
    v_xor_b32 v68, v36, v68
    v_xor_b32 v69, v37, v69
    v_xor_b32 v70, v38, v70
    v_xor_b32 v71, v39, v71
    v_xor_b32 v72, v36, v72
    v_xor_b32 v73, v37, v73
    v_xor_b32 v74, v38, v74
    v_xor_b32 v75, v39, v75
    v_xor_b32 v76, v36, v76
    v_xor_b32 v77, v37, v77
    v_xor_b32 v78, v38, v78
    v_xor_b32 v79, v39, v79
    v_xor_b32 v80, v36, v80
    v_xor_b32 v81, v37, v81
    v_xor_b32 v82, v38, v82
    v_xor_b32 v83, v39, v83
    v_xor_b32 v84, v36, v84
    v_xor_b32 v85, v37, v85
    v_xor_b32 v86, v38, v86
    v_xor_b32 v87, v39, v87
    v_xor_b32 v88, v36, v88
    v_xor_b32 v89, v37, v89
    v_xor_b32 v90, v38, v90
    v_xor_b32 v91, v39, v91
    v_xor_b32 v92, v36, v92
    v_xor_b32 v93, v37, v93
    v_xor_b32 v94, v38, v94
    v_xor_b32 v95, v39, v95
    v_or_b32 v14, v64, v65
    v_or3_b32 v14, v14, v66, v67
    v_or3_b32 v14, v14, v68, v69
    v_or3_b32 v14, v14, v70, v71
    v_or3_b32 v14, v14, v72, v73
    v_or3_b32 v14, v14, v74, v75
    v_or3_b32 v14, v14, v76, v77
    v_or3_b32 v14, v14, v78, v79
    v_or3_b32 v14, v14, v80, v81
    v_or3_b32 v14, v14, v82, v83
    v_or3_b32 v14, v14, v84, v85
    v_or3_b32 v14, v14, v86, v87
    v_or3_b32 v14, v14, v88, v89
    v_or3_b32 v14, v14, v90, v91
    v_or3_b32 v14, v14, v92, v93
    v_or3_b32 v14, v14, v94, v95
    v_and_b32 v14, 15, v14
    v_cmp_ne_u32 vcc, 0, v14
    s_cbranch_vccz L_qok
    s_sleep 4
    s_add_u32 s84, s84, 1
    s_cmp_lt_u32 s84, 16
    s_cbranch_scc1 L_qpoll
    s_cmp_lg_u32 s84, 16
    s_cbranch_scc1 L_qflip
    s_xor_b32 s71, s71, 49152
    s_mov_b32 exec_lo, 0x00ff00ff
    s_mov_b32 exec_hi, 0x00ff00ff
    buffer_store_dwordx2 v[34:35], v6, s[36:39], s71 offen sc1
    s_mov_b64 exec, -1
L_qflip:
    s_xor_b32 s74, s74, 49152
    s_xor_b32 s75, s75, 49152
    s_xor_b32 s14, s14, 3
    v_xor_b32 v36, s78, v36
    v_xor_b32 v37, s78, v37
    v_xor_b32 v38, s78, v38
    v_xor_b32 v39, s78, v39
    s_cmp_lt_u32 s84, s15
    s_cbranch_scc1 L_qpoll
L_qok:
    v_add_f32 v64, v64, v72
    v_add_f32 v80, v80, v88
    v_add_f32 v65, v65, v73
    v_add_f32 v81, v81, v89
    v_add_f32 v66, v66, v74
    v_add_f32 v82, v82, v90
    v_add_f32 v67, v67, v75
    v_add_f32 v83, v83, v91
    v_add_f32 v68, v68, v76
    v_add_f32 v84, v84, v92
    v_add_f32 v69, v69, v77
    v_add_f32 v85, v85, v93
    v_add_f32 v70, v70, v78
    v_add_f32 v86, v86, v94
    v_add_f32 v71, v71, v79
    v_add_f32 v87, v87, v95
    v_add_f32 v64, v64, v80
    v_add_f32 v65, v65, v81
    v_add_f32 v66, v66, v82
    v_add_f32 v67, v67, v83
    v_add_f32 v68, v68, v84
    v_add_f32 v69, v69, v85
    v_add_f32 v70, v70, v86
    v_add_f32 v71, v71, v87
    v_cvt_pk_bf16_f32 v64, v64, v65
    v_cvt_pk_bf16_f32 v65, v66, v67
    v_cvt_pk_bf16_f32 v66, v68, v69
    v_cvt_pk_bf16_f32 v67, v70, v71
    v_lshrrev_b32 v6, 4, v1
    v_lshlrev_b32 v6, 7, v6
    v_and_b32 v5, 3, v1
    v_lshl_add_u32 v6, v5, 5, v6
    v_and_b32 v5, 12, v1
    v_add_u32 v6, v6, v5
    ds_write_b32 v6, v64 offset:0
    ds_write_b32 v6, v65 offset:16
    ds_write_b32 v6, v66 offset:512
    ds_write_b32 v6, v67 offset:528
    v_mov_b32 v14, s14
    ds_write_b32 v7, v14 offset:1040
L_qwait:
    s_lshl_b32 s72, s61, 2
    v_mov_b32 v30, s72
    v_xor_b32 v31, 4, v30
    v_and_b32 v5, 3, v1
    v_lshlrev_b32 v5, 10, v5
    v_bfe_u32 v6, v1, 2, 2
    v_lshl_add_u32 v5, v6, 8, v5
    v_lshrrev_b32 v6, 4, v1
    v_xor_b32 v6, v6, v1
    v_and_b32 v6, 15, v6
    v_lshl_add_u32 v184, v6, 4, v5
    v_xor_b32 v185, 64, v184
    v_xor_b32 v186, 128, v184
    v_xor_b32 v187, 192, v184
    v_and_b32 v5, 3, v1
    v_lshlrev_b32 v5, 6, v5
    v_lshrrev_b32 v6, 4, v1
    v_lshl_add_u32 v5, v6, 4, v5
    v_mov_b32 v29, v5
    v_and_b32 v6, 8, v1
    v_lshl_add_u32 v5, v6, 5, v5
    v_and_b32 v6, 4, v1
    v_lshl_add_u32 v5, v6, 1, v5
    s_lshl_b32 s72, s61, 9
    v_add_u32 v188, s72, v5
    v_mov_b32 v172, 0xff61b1e6
    s_add_u32 s72, s61, 2
    v_mov_b32 v189, s72
    v_and_b32 v6, 3, v1
    v_lshlrev_b32 v6, 8, v6
    v_lshrrev_b32 v5, 4, v1
    v_lshl_add_u32 v6, v5, 4, v6
    s_mov_b32 s3, 0
    s_mov_b32 s84, 0
L_qh_15:
    ds_read_b32 v14, v7 offset:1040
    s_waitcnt lgkmcnt(0)
    v_readfirstlane_b32 s14, v14
    s_add_u32 s84, s84, 1
    s_cmp_ge_i32 s14, 1
    s_cbranch_scc1 L_qh_ok_16
    s_sleep 1
    s_cmp_lt_u32 s84, 0x100000
    s_cbranch_scc1 L_qh_15
L_qh_ok_16:
    ds_read_b128 v[96:99], v6 offset:0
    ds_read_b128 v[100:103], v6 offset:64
    ds_read_b128 v[104:107], v6 offset:128
    ds_read_b128 v[108:111], v6 offset:192
    s_waitcnt lgkmcnt(0)
    s_mov_b32 vcc_lo, 0xf000f
    s_mov_b32 vcc_hi, 0xf000f
    v_cndmask_b32 v32, 0, v96, vcc
    v_cndmask_b32 v33, 0, v97, vcc
    v_cndmask_b32 v34, 0, v98, vcc
    v_cndmask_b32 v35, 0, v99, vcc
    v_cndmask_b32 v36, 0, v100, vcc
    v_cndmask_b32 v37, 0, v101, vcc
    v_cndmask_b32 v38, 0, v102, vcc
    v_cndmask_b32 v39, 0, v103, vcc
    v_cndmask_b32 v40, 0, v104, vcc
    v_cndmask_b32 v41, 0, v105, vcc
    v_cndmask_b32 v42, 0, v106, vcc
    v_cndmask_b32 v43, 0, v107, vcc
    v_cndmask_b32 v44, 0, v108, vcc
    v_cndmask_b32 v45, 0, v109, vcc
    v_cndmask_b32 v46, 0, v110, vcc
    v_cndmask_b32 v47, 0, v111, vcc
    s_mov_b32 vcc_lo, 0xf000f0
    s_mov_b32 vcc_hi, 0xf000f0
    v_cndmask_b32 v48, 0, v96, vcc
    v_cndmask_b32 v49, 0, v97, vcc
    v_cndmask_b32 v50, 0, v98, vcc
    v_cndmask_b32 v51, 0, v99, vcc
    v_cndmask_b32 v52, 0, v100, vcc
    v_cndmask_b32 v53, 0, v101, vcc
    v_cndmask_b32 v54, 0, v102, vcc
    v_cndmask_b32 v55, 0, v103, vcc
    v_cndmask_b32 v56, 0, v104, vcc
    v_cndmask_b32 v57, 0, v105, vcc
    v_cndmask_b32 v58, 0, v106, vcc
    v_cndmask_b32 v59, 0, v107, vcc
    v_cndmask_b32 v60, 0, v108, vcc
    v_cndmask_b32 v61, 0, v109, vcc
    v_cndmask_b32 v62, 0, v110, vcc
    v_cndmask_b32 v63, 0, v111, vcc
    s_mov_b32 vcc_lo, 0xf000f00
    s_mov_b32 vcc_hi, 0xf000f00
    v_cndmask_b32 v64, 0, v96, vcc
    v_cndmask_b32 v65, 0, v97, vcc
    v_cndmask_b32 v66, 0, v98, vcc
    v_cndmask_b32 v67, 0, v99, vcc
    v_cndmask_b32 v68, 0, v100, vcc
    v_cndmask_b32 v69, 0, v101, vcc
    v_cndmask_b32 v70, 0, v102, vcc
    v_cndmask_b32 v71, 0, v103, vcc
    v_cndmask_b32 v72, 0, v104, vcc
    v_cndmask_b32 v73, 0, v105, vcc
    v_cndmask_b32 v74, 0, v106, vcc
    v_cndmask_b32 v75, 0, v107, vcc
    v_cndmask_b32 v76, 0, v108, vcc
    v_cndmask_b32 v77, 0, v109, vcc
    v_cndmask_b32 v78, 0, v110, vcc
    v_cndmask_b32 v79, 0, v111, vcc
    s_mov_b32 vcc_lo, 0xf000f000
    s_mov_b32 vcc_hi, 0xf000f000
    v_cndmask_b32 v80, 0, v96, vcc
    v_cndmask_b32 v81, 0, v97, vcc
    v_cndmask_b32 v82, 0, v98, vcc
    v_cndmask_b32 v83, 0, v99, vcc
    v_cndmask_b32 v84, 0, v100, vcc
    v_cndmask_b32 v85, 0, v101, vcc
    v_cndmask_b32 v86, 0, v102, vcc
    v_cndmask_b32 v87, 0, v103, vcc
    v_cndmask_b32 v88, 0, v104, vcc
    v_cndmask_b32 v89, 0, v105, vcc
    v_cndmask_b32 v90, 0, v106, vcc
    v_cndmask_b32 v91, 0, v107, vcc
    v_cndmask_b32 v92, 0, v108, vcc
    v_cndmask_b32 v93, 0, v109, vcc
    v_cndmask_b32 v94, 0, v110, vcc
    v_cndmask_b32 v95, 0, v111, vcc
    s_lshl_b32 s85, s61, 14
    s_lshl_b32 s62, s61, 4
    s_add_u32 s62, s62, 56
    s_mov_b32 s63, 0
L_p1:
    v_add_u32 v176, s85, v184
    v_add_u32 v177, s85, v185
    v_add_u32 v178, s85, v186
    v_add_u32 v179, s85, v187
    s_cmp_ge_i32 s3, s62
    s_cbranch_scc1 L_krdy_ok_18
    s_mov_b32 s84, 0
L_krdy_17:
    ds_read_b32 v14, v7 offset:1024
    s_waitcnt lgkmcnt(0)
    v_readfirstlane_b32 s3, v14
    s_add_u32 s84, s84, 1
    s_cmp_ge_i32 s3, s62
    s_cbranch_scc1 L_krdy_ok_18
    s_cmp_lt_u32 s84, 0x100000
    s_cbranch_scc1 L_krdy_17
L_krdy_ok_18:
    ds_read_b128 v[96:99], v176 offset:28672
    ds_read_b128 v[100:103], v177 offset:28672
    ds_read_b128 v[104:107], v178 offset:28672
    ds_read_b128 v[108:111], v179 offset:28672
    ds_read_b128 v[112:115], v176 offset:32768
    ds_read_b128 v[116:119], v177 offset:32768
    ds_read_b128 v[120:123], v178 offset:32768
    ds_read_b128 v[124:127], v179 offset:32768
    ds_read_b128 v[128:131], v176 offset:36864
    ds_read_b128 v[132:135], v177 offset:36864
    ds_read_b128 v[136:139], v178 offset:36864
    ds_read_b128 v[140:143], v179 offset:36864
    ds_read_b128 v[144:147], v176 offset:40960
    ds_read_b128 v[148:151], v177 offset:40960
    ds_read_b128 v[152:155], v178 offset:40960
    ds_read_b128 v[156:159], v179 offset:40960
    s_waitcnt lgkmcnt(12)
    v_mfma_f32_16x16x32_bf16 v[160:163], v[96:99], v[32:35], 0
    v_mfma_f32_16x16x32_bf16 v[160:163], v[100:103], v[36:39], v[160:163]
    v_mfma_f32_16x16x32_bf16 v[160:163], v[104:107], v[40:43], v[160:163]
    v_mfma_f32_16x16x32_bf16 v[160:163], v[108:111], v[44:47], v[160:163]
    s_waitcnt lgkmcnt(8)
    v_mfma_f32_16x16x32_bf16 v[160:163], v[112:115], v[48:51], v[160:163]
    v_mfma_f32_16x16x32_bf16 v[160:163], v[116:119], v[52:55], v[160:163]
    v_mfma_f32_16x16x32_bf16 v[160:163], v[120:123], v[56:59], v[160:163]
    v_mfma_f32_16x16x32_bf16 v[160:163], v[124:127], v[60:63], v[160:163]
    s_waitcnt lgkmcnt(4)
    v_mfma_f32_16x16x32_bf16 v[160:163], v[128:131], v[64:67], v[160:163]
    v_mfma_f32_16x16x32_bf16 v[160:163], v[132:135], v[68:71], v[160:163]
    v_mfma_f32_16x16x32_bf16 v[160:163], v[136:139], v[72:75], v[160:163]
    v_mfma_f32_16x16x32_bf16 v[160:163], v[140:143], v[76:79], v[160:163]
    s_waitcnt lgkmcnt(0)
    ds_write_b32 v30, v189 offset:1032
    v_mfma_f32_16x16x32_bf16 v[160:163], v[144:147], v[80:83], v[160:163]
    v_mfma_f32_16x16x32_bf16 v[160:163], v[148:151], v[84:87], v[160:163]
    v_mfma_f32_16x16x32_bf16 v[160:163], v[152:155], v[88:91], v[160:163]
    v_mfma_f32_16x16x32_bf16 v[160:163], v[156:159], v[92:95], v[160:163]
    v_add_u32 v189, 2, v189
    v_min_u32 v189, 32, v189
    s_add_u32 s85, s85, 32768
    s_and_b32 s85, s85, 131071
    s_add_u32 s62, s62, 32
    s_add_u32 s63, s63, 1
    s_nop 3
    v_cvt_pk_bf16_f32 v164, v160, v161
    v_cvt_pk_bf16_f32 v165, v162, v163
    v_max3_f32 v172, v172, v160, v161
    v_max3_f32 v172, v172, v162, v163
    v_lshlrev_b32 v166, 16, v164
    v_and_b32 v167, s69, v164
    v_lshlrev_b32 v168, 16, v165
    v_and_b32 v169, s69, v165
    v_mul_f32 v166, s67, v166
    v_mul_f32 v167, s67, v167
    v_mul_f32 v168, s67, v168
    v_mul_f32 v169, s67, v169
    v_cvt_pk_bf16_f32 v164, v166, v167
    v_cvt_pk_bf16_f32 v165, v168, v169
    ds_write_b64 v188, v[164:165] offset:4096
    v_add_u32 v188, 1024, v188
    s_cmp_lt_u32 s63, 16
    s_cbranch_scc1 L_p1
    s_nop 1
    v_max_f32 v172, v172, v172 row_ror:8
    s_nop 1
    v_max_f32 v172, v172, v172 row_ror:4
    v_mov_b32 v14, v172
    s_nop 1
    v_permlane16_swap_b32 v172, v14
    s_nop 1
    v_max_f32 v172, v172, v14
    v_mov_b32 v14, v172
    s_nop 1
    v_permlane32_swap_b32 v172, v14
    s_nop 1
    v_max_f32 v172, v172, v14
    v_and_b32 v5, 3, v1
    v_lshlrev_b32 v5, 2, v5
    v_lshl_add_u32 v6, v30, 2, v5
    v_xor_b32 v5, 16, v6
    ds_write_b32 v6, v172 offset:1152
    v_mov_b32 v14, 1
    ds_write_b32 v30, v14 offset:1048
    v_subrev_u32 v188, 16384, v188
    s_mov_b32 s84, 0
L_mx_19:
    ds_read_b32 v14, v31 offset:1048
    s_waitcnt lgkmcnt(0)
    v_readfirstlane_b32 s70, v14
    s_add_u32 s84, s84, 1
    s_cmp_ge_i32 s70, 1
    s_cbranch_scc1 L_mx_ok_20
    s_cmp_lt_u32 s84, 0x100000
    s_cbranch_scc1 L_mx_19
L_mx_ok_20:
    ds_read_b32 v15, v5 offset:1152
    ds_read_b64 v[32:33], v188 offset:4096
    ds_read_b64 v[34:35], v188 offset:5120
    ds_read_b64 v[36:37], v188 offset:6144
    ds_read_b64 v[38:39], v188 offset:7168
    ds_read_b64 v[40:41], v188 offset:8192
    ds_read_b64 v[42:43], v188 offset:9216
    ds_read_b64 v[44:45], v188 offset:10240
    ds_read_b64 v[46:47], v188 offset:11264
    ds_read_b64 v[48:49], v188 offset:12288
    ds_read_b64 v[50:51], v188 offset:13312
    ds_read_b64 v[52:53], v188 offset:14336
    ds_read_b64 v[54:55], v188 offset:15360
    ds_read_b64 v[56:57], v188 offset:16384
    ds_read_b64 v[58:59], v188 offset:17408
    ds_read_b64 v[60:61], v188 offset:18432
    ds_read_b64 v[62:63], v188 offset:19456
    s_waitcnt lgkmcnt(0)
    v_max_f32 v172, v172, v15
    v_cvt_pk_bf16_f32 v172, v172, v172
    v_and_b32 v172, 0xffff0000, v172
    v_mul_f32 v172, s67, v172
    v_cvt_pk_bf16_f32 v172, v172, v172
    v_and_b32 v172, 0xffff0000, v172
    v_mul_f32 v173, s68, v172
    v_mov_b32 v174, 0
    v_lshlrev_b32 v96, 16, v32
    v_and_b32 v97, s69, v32
    v_lshlrev_b32 v98, 16, v33
    v_and_b32 v99, s69, v33
    v_lshlrev_b32 v100, 16, v34
    v_and_b32 v101, s69, v34
    v_lshlrev_b32 v102, 16, v35
    v_and_b32 v103, s69, v35
    v_fma_f32 v96, v96, s68, -v173
    v_fma_f32 v97, v97, s68, -v173
    v_fma_f32 v98, v98, s68, -v173
    v_fma_f32 v99, v99, s68, -v173
    v_fma_f32 v100, v100, s68, -v173
    v_fma_f32 v101, v101, s68, -v173
    v_fma_f32 v102, v102, s68, -v173
    v_fma_f32 v103, v103, s68, -v173
    v_exp_f32 v96, v96
    v_exp_f32 v97, v97
    v_exp_f32 v98, v98
    v_exp_f32 v99, v99
    v_exp_f32 v100, v100
    v_exp_f32 v101, v101
    v_exp_f32 v102, v102
    v_exp_f32 v103, v103
    s_nop 0
    v_cvt_pk_bf16_f32 v32, v96, v97
    v_cvt_pk_bf16_f32 v33, v98, v99
    v_cvt_pk_bf16_f32 v34, v100, v101
    v_cvt_pk_bf16_f32 v35, v102, v103
    ds_write_b64 v188, v[32:33] offset:4096
    ds_write_b64 v188, v[34:35] offset:5120
    v_add_f32 v96, v96, v100
    v_add_f32 v97, v97, v101
    v_add_f32 v98, v98, v102
    v_add_f32 v99, v99, v103
    v_add_f32 v96, v96, v97
    v_add_f32 v98, v98, v99
    v_add_f32 v174, v174, v96
    v_add_f32 v174, v174, v98
    v_lshlrev_b32 v96, 16, v36
    v_and_b32 v97, s69, v36
    v_lshlrev_b32 v98, 16, v37
    v_and_b32 v99, s69, v37
    v_lshlrev_b32 v100, 16, v38
    v_and_b32 v101, s69, v38
    v_lshlrev_b32 v102, 16, v39
    v_and_b32 v103, s69, v39
    v_fma_f32 v96, v96, s68, -v173
    v_fma_f32 v97, v97, s68, -v173
    v_fma_f32 v98, v98, s68, -v173
    v_fma_f32 v99, v99, s68, -v173
    v_fma_f32 v100, v100, s68, -v173
    v_fma_f32 v101, v101, s68, -v173
    v_fma_f32 v102, v102, s68, -v173
    v_fma_f32 v103, v103, s68, -v173
    v_exp_f32 v96, v96
    v_exp_f32 v97, v97
    v_exp_f32 v98, v98
    v_exp_f32 v99, v99
    v_exp_f32 v100, v100
    v_exp_f32 v101, v101
    v_exp_f32 v102, v102
    v_exp_f32 v103, v103
    s_nop 0
    v_cvt_pk_bf16_f32 v36, v96, v97
    v_cvt_pk_bf16_f32 v37, v98, v99
    v_cvt_pk_bf16_f32 v38, v100, v101
    v_cvt_pk_bf16_f32 v39, v102, v103
    ds_write_b64 v188, v[36:37] offset:6144
    ds_write_b64 v188, v[38:39] offset:7168
    v_add_f32 v96, v96, v100
    v_add_f32 v97, v97, v101
    v_add_f32 v98, v98, v102
    v_add_f32 v99, v99, v103
    v_add_f32 v96, v96, v97
    v_add_f32 v98, v98, v99
    v_add_f32 v174, v174, v96
    v_add_f32 v174, v174, v98
    v_lshlrev_b32 v96, 16, v40
    v_and_b32 v97, s69, v40
    v_lshlrev_b32 v98, 16, v41
    v_and_b32 v99, s69, v41
    v_lshlrev_b32 v100, 16, v42
    v_and_b32 v101, s69, v42
    v_lshlrev_b32 v102, 16, v43
    v_and_b32 v103, s69, v43
    v_fma_f32 v96, v96, s68, -v173
    v_fma_f32 v97, v97, s68, -v173
    v_fma_f32 v98, v98, s68, -v173
    v_fma_f32 v99, v99, s68, -v173
    v_fma_f32 v100, v100, s68, -v173
    v_fma_f32 v101, v101, s68, -v173
    v_fma_f32 v102, v102, s68, -v173
    v_fma_f32 v103, v103, s68, -v173
    v_exp_f32 v96, v96
    v_exp_f32 v97, v97
    v_exp_f32 v98, v98
    v_exp_f32 v99, v99
    v_exp_f32 v100, v100
    v_exp_f32 v101, v101
    v_exp_f32 v102, v102
    v_exp_f32 v103, v103
    s_nop 0
    v_cvt_pk_bf16_f32 v40, v96, v97
    v_cvt_pk_bf16_f32 v41, v98, v99
    v_cvt_pk_bf16_f32 v42, v100, v101
    v_cvt_pk_bf16_f32 v43, v102, v103
    ds_write_b64 v188, v[40:41] offset:8192
    ds_write_b64 v188, v[42:43] offset:9216
    v_add_f32 v96, v96, v100
    v_add_f32 v97, v97, v101
    v_add_f32 v98, v98, v102
    v_add_f32 v99, v99, v103
    v_add_f32 v96, v96, v97
    v_add_f32 v98, v98, v99
    v_add_f32 v174, v174, v96
    v_add_f32 v174, v174, v98
    v_lshlrev_b32 v96, 16, v44
    v_and_b32 v97, s69, v44
    v_lshlrev_b32 v98, 16, v45
    v_and_b32 v99, s69, v45
    v_lshlrev_b32 v100, 16, v46
    v_and_b32 v101, s69, v46
    v_lshlrev_b32 v102, 16, v47
    v_and_b32 v103, s69, v47
    v_fma_f32 v96, v96, s68, -v173
    v_fma_f32 v97, v97, s68, -v173
    v_fma_f32 v98, v98, s68, -v173
    v_fma_f32 v99, v99, s68, -v173
    v_fma_f32 v100, v100, s68, -v173
    v_fma_f32 v101, v101, s68, -v173
    v_fma_f32 v102, v102, s68, -v173
    v_fma_f32 v103, v103, s68, -v173
    v_exp_f32 v96, v96
    v_exp_f32 v97, v97
    v_exp_f32 v98, v98
    v_exp_f32 v99, v99
    v_exp_f32 v100, v100
    v_exp_f32 v101, v101
    v_exp_f32 v102, v102
    v_exp_f32 v103, v103
    s_nop 0
    v_cvt_pk_bf16_f32 v44, v96, v97
    v_cvt_pk_bf16_f32 v45, v98, v99
    v_cvt_pk_bf16_f32 v46, v100, v101
    v_cvt_pk_bf16_f32 v47, v102, v103
    ds_write_b64 v188, v[44:45] offset:10240
    ds_write_b64 v188, v[46:47] offset:11264
    v_add_f32 v96, v96, v100
    v_add_f32 v97, v97, v101
    v_add_f32 v98, v98, v102
    v_add_f32 v99, v99, v103
    v_add_f32 v96, v96, v97
    v_add_f32 v98, v98, v99
    v_add_f32 v174, v174, v96
    v_add_f32 v174, v174, v98
    v_lshlrev_b32 v96, 16, v48
    v_and_b32 v97, s69, v48
    v_lshlrev_b32 v98, 16, v49
    v_and_b32 v99, s69, v49
    v_lshlrev_b32 v100, 16, v50
    v_and_b32 v101, s69, v50
    v_lshlrev_b32 v102, 16, v51
    v_and_b32 v103, s69, v51
    v_fma_f32 v96, v96, s68, -v173
    v_fma_f32 v97, v97, s68, -v173
    v_fma_f32 v98, v98, s68, -v173
    v_fma_f32 v99, v99, s68, -v173
    v_fma_f32 v100, v100, s68, -v173
    v_fma_f32 v101, v101, s68, -v173
    v_fma_f32 v102, v102, s68, -v173
    v_fma_f32 v103, v103, s68, -v173
    v_exp_f32 v96, v96
    v_exp_f32 v97, v97
    v_exp_f32 v98, v98
    v_exp_f32 v99, v99
    v_exp_f32 v100, v100
    v_exp_f32 v101, v101
    v_exp_f32 v102, v102
    v_exp_f32 v103, v103
    s_nop 0
    v_cvt_pk_bf16_f32 v48, v96, v97
    v_cvt_pk_bf16_f32 v49, v98, v99
    v_cvt_pk_bf16_f32 v50, v100, v101
    v_cvt_pk_bf16_f32 v51, v102, v103
    ds_write_b64 v188, v[48:49] offset:12288
    ds_write_b64 v188, v[50:51] offset:13312
    v_add_f32 v96, v96, v100
    v_add_f32 v97, v97, v101
    v_add_f32 v98, v98, v102
    v_add_f32 v99, v99, v103
    v_add_f32 v96, v96, v97
    v_add_f32 v98, v98, v99
    v_add_f32 v174, v174, v96
    v_add_f32 v174, v174, v98
    v_lshlrev_b32 v96, 16, v52
    v_and_b32 v97, s69, v52
    v_lshlrev_b32 v98, 16, v53
    v_and_b32 v99, s69, v53
    v_lshlrev_b32 v100, 16, v54
    v_and_b32 v101, s69, v54
    v_lshlrev_b32 v102, 16, v55
    v_and_b32 v103, s69, v55
    v_fma_f32 v96, v96, s68, -v173
    v_fma_f32 v97, v97, s68, -v173
    v_fma_f32 v98, v98, s68, -v173
    v_fma_f32 v99, v99, s68, -v173
    v_fma_f32 v100, v100, s68, -v173
    v_fma_f32 v101, v101, s68, -v173
    v_fma_f32 v102, v102, s68, -v173
    v_fma_f32 v103, v103, s68, -v173
    v_exp_f32 v96, v96
    v_exp_f32 v97, v97
    v_exp_f32 v98, v98
    v_exp_f32 v99, v99
    v_exp_f32 v100, v100
    v_exp_f32 v101, v101
    v_exp_f32 v102, v102
    v_exp_f32 v103, v103
    s_nop 0
    v_cvt_pk_bf16_f32 v52, v96, v97
    v_cvt_pk_bf16_f32 v53, v98, v99
    v_cvt_pk_bf16_f32 v54, v100, v101
    v_cvt_pk_bf16_f32 v55, v102, v103
    ds_write_b64 v188, v[52:53] offset:14336
    ds_write_b64 v188, v[54:55] offset:15360
    v_add_f32 v96, v96, v100
    v_add_f32 v97, v97, v101
    v_add_f32 v98, v98, v102
    v_add_f32 v99, v99, v103
    v_add_f32 v96, v96, v97
    v_add_f32 v98, v98, v99
    v_add_f32 v174, v174, v96
    v_add_f32 v174, v174, v98
    v_lshlrev_b32 v96, 16, v56
    v_and_b32 v97, s69, v56
    v_lshlrev_b32 v98, 16, v57
    v_and_b32 v99, s69, v57
    v_lshlrev_b32 v100, 16, v58
    v_and_b32 v101, s69, v58
    v_lshlrev_b32 v102, 16, v59
    v_and_b32 v103, s69, v59
    v_fma_f32 v96, v96, s68, -v173
    v_fma_f32 v97, v97, s68, -v173
    v_fma_f32 v98, v98, s68, -v173
    v_fma_f32 v99, v99, s68, -v173
    v_fma_f32 v100, v100, s68, -v173
    v_fma_f32 v101, v101, s68, -v173
    v_fma_f32 v102, v102, s68, -v173
    v_fma_f32 v103, v103, s68, -v173
    v_exp_f32 v96, v96
    v_exp_f32 v97, v97
    v_exp_f32 v98, v98
    v_exp_f32 v99, v99
    v_exp_f32 v100, v100
    v_exp_f32 v101, v101
    v_exp_f32 v102, v102
    v_exp_f32 v103, v103
    s_nop 0
    v_cvt_pk_bf16_f32 v56, v96, v97
    v_cvt_pk_bf16_f32 v57, v98, v99
    v_cvt_pk_bf16_f32 v58, v100, v101
    v_cvt_pk_bf16_f32 v59, v102, v103
    ds_write_b64 v188, v[56:57] offset:16384
    ds_write_b64 v188, v[58:59] offset:17408
    v_add_f32 v96, v96, v100
    v_add_f32 v97, v97, v101
    v_add_f32 v98, v98, v102
    v_add_f32 v99, v99, v103
    v_add_f32 v96, v96, v97
    v_add_f32 v98, v98, v99
    v_add_f32 v174, v174, v96
    v_add_f32 v174, v174, v98
    v_lshlrev_b32 v96, 16, v60
    v_and_b32 v97, s69, v60
    v_lshlrev_b32 v98, 16, v61
    v_and_b32 v99, s69, v61
    v_lshlrev_b32 v100, 16, v62
    v_and_b32 v101, s69, v62
    v_lshlrev_b32 v102, 16, v63
    v_and_b32 v103, s69, v63
    v_fma_f32 v96, v96, s68, -v173
    v_fma_f32 v97, v97, s68, -v173
    v_fma_f32 v98, v98, s68, -v173
    v_fma_f32 v99, v99, s68, -v173
    v_fma_f32 v100, v100, s68, -v173
    v_fma_f32 v101, v101, s68, -v173
    v_fma_f32 v102, v102, s68, -v173
    v_fma_f32 v103, v103, s68, -v173
    v_exp_f32 v96, v96
    v_exp_f32 v97, v97
    v_exp_f32 v98, v98
    v_exp_f32 v99, v99
    v_exp_f32 v100, v100
    v_exp_f32 v101, v101
    v_exp_f32 v102, v102
    v_exp_f32 v103, v103
    s_nop 0
    v_cvt_pk_bf16_f32 v60, v96, v97
    v_cvt_pk_bf16_f32 v61, v98, v99
    v_cvt_pk_bf16_f32 v62, v100, v101
    v_cvt_pk_bf16_f32 v63, v102, v103
    ds_write_b64 v188, v[60:61] offset:18432
    ds_write_b64 v188, v[62:63] offset:19456
    v_add_f32 v96, v96, v100
    v_add_f32 v97, v97, v101
    v_add_f32 v98, v98, v102
    v_add_f32 v99, v99, v103
    v_add_f32 v96, v96, v97
    v_add_f32 v98, v98, v99
    v_add_f32 v174, v174, v96
    v_add_f32 v174, v174, v98
    s_nop 1
    v_add_f32 v174, v174, v174 row_ror:8
    s_nop 1
    v_add_f32 v174, v174, v174 row_ror:4
    v_mov_b32 v14, v174
    s_nop 1
    v_permlane16_swap_b32 v174, v14
    s_nop 1
    v_add_f32 v174, v174, v14
    v_mov_b32 v14, v174
    s_nop 1
    v_permlane32_swap_b32 v174, v14
    s_nop 1
    v_add_f32 v174, v174, v14
    v_lshlrev_b32 v6, 1, v6
    v_mov_b32 v175, v173
    ds_write_b64 v6, v[174:175] offset:1216
    v_mov_b32 v14, 1
    ds_write_b32 v30, v14 offset:1056
    v_and_b32 v5, 12, v1
    v_lshrrev_b32 v6, 4, v1
    v_add_u32 v6, v6, v5
    v_lshlrev_b32 v6, 8, v6
    v_lshrrev_b32 v15, 3, v1
    v_and_b32 v15, 2, v15
    v_or_b32 v5, v5, v15
    v_bfe_u32 v15, v1, 1, 1
    v_xor_b32 v5, v5, v15
    s_lshl_b32 s72, s61, 3
    v_xor_b32 v5, s72, v5
    v_lshl_add_u32 v6, v5, 4, v6
    v_and_b32 v5, 1, v1
    v_lshl_add_u32 v184, v5, 3, v6
    v_xor_b32 v185, 32, v184
    v_xor_b32 v186, 64, v184
    v_xor_b32 v187, 96, v184
    v_mov_b32 v32, 0
    v_mov_b32 v33, 0
    v_mov_b32 v34, 0
    v_mov_b32 v35, 0
    v_mov_b32 v80, 0
    v_mov_b32 v81, 0
    v_mov_b32 v82, 0
    v_mov_b32 v83, 0
    v_mov_b32 v84, 0
    v_mov_b32 v85, 0
    v_mov_b32 v86, 0
    v_mov_b32 v87, 0
    v_mov_b32 v88, 0
    v_mov_b32 v89, 0
    v_mov_b32 v90, 0
    v_mov_b32 v91, 0
    v_mov_b32 v92, 0
    v_mov_b32 v93, 0
    v_mov_b32 v94, 0
    v_mov_b32 v95, 0
    v_mov_b32 v96, 0
    v_mov_b32 v97, 0
    v_mov_b32 v98, 0
    v_mov_b32 v99, 0
    v_mov_b32 v100, 0
    v_mov_b32 v101, 0
    v_mov_b32 v102, 0
    v_mov_b32 v103, 0
    v_mov_b32 v104, 0
    v_mov_b32 v105, 0
    v_mov_b32 v106, 0
    v_mov_b32 v107, 0
    v_mov_b32 v108, 0
    v_mov_b32 v109, 0
    v_mov_b32 v110, 0
    v_mov_b32 v111, 0
    s_mov_b32 s48, 0xf000f
    s_mov_b32 s49, s48
    s_mov_b32 s50, 0xf000f0
    s_mov_b32 s51, s50
    s_mov_b32 s52, 0xf000f00
    s_mov_b32 s53, s52
    s_mov_b32 s54, 0xf000f000
    s_mov_b32 s55, s54
    v_mov_b32 v189, 33
    v_mov_b32 v188, v29
    s_mov_b32 s85, 0
    s_mov_b32 s62, 560
    s_mov_b32 s63, 0
    v_bfe_u32 v5, v1, 2, 3
    v_lshlrev_b32 v5, 7, v5
    v_lshrrev_b32 v6, 5, v1
    v_lshl_add_u32 v5, v6, 17, v5
    v_and_b32 v215, 3, v1
    v_lshl_add_u32 v214, v215, 4, v5
    v_lshl_add_u32 v215, v215, 1, v6
    v_lshlrev_b32 v215, 2, v215
    v_bfe_u32 v5, v1, 2, 2
    v_mul_u32_u24 v5, 0x140, v5
    v_lshrrev_b32 v6, 4, v1
    v_lshlrev_b32 v6, 5, v6
    v_xor_b32 v5, v5, v6
    v_and_b32 v6, 3, v1
    v_lshl_add_u32 v5, v6, 3, v5
    s_lshl_b32 s72, s82, 12
    v_add_u32 v212, s72, v5
    v_xor_b32 v213, 0x80, v212
    s_and_b32 s72, s58, 28
    s_add_u32 s72, s72, s82
    s_lshl_b32 s72, s72, 11
    s_add_u32 s24, s0, s72
    s_lshl_b32 s72, s82, 9
    s_add_u32 s72, s72, 2048
    v_lshl_add_u32 v208, v1, 2, s72
    v_lshlrev_b32 v209, 3, v1
    v_and_b32 v5, 15, v1
    v_lshlrev_b32 v5, 3, v5
    v_lshrrev_b32 v6, 4, v1
    v_lshl_add_u32 v210, v6, 10, v5
    s_and_b32 s25, s58, 3
    s_lshl_b32 s25, s25, 12
    s_add_u32 s25, s25, s0
    s_lshr_b32 s72, s58, 2
    s_lshl_b32 s72, s72, 7
    s_add_u32 s25, s25, s72
    s_add_u32 s25, s25, 86016
    v_lshrrev_b32 v6, 2, v1
    v_lshlrev_b32 v6, 11, v6
    v_and_b32 v5, 3, v1
    v_lshl_add_u32 v211, v5, 4, v6
    s_lshl_b32 s72, s61, 15
    s_add_u32 s71, s0, s72
    s_lshl_b32 s72, s58, 6
    s_add_u32 s71, s71, s72
    s_mov_b32 s84, 0
L_pd_21:
    ds_read_b32 v14, v31 offset:1056
    s_waitcnt lgkmcnt(0)
    v_readfirstlane_b32 s70, v14
    s_add_u32 s84, s84, 1
    s_cmp_ge_i32 s70, 1
    s_cbranch_scc1 L_pd_ok_22
    s_cmp_lt_u32 s84, 0x100000
    s_cbranch_scc1 L_pd_21
L_pd_ok_22:
L_p2:
    v_add_u32 v176, s85, v184
    v_add_u32 v177, s85, v185
    v_add_u32 v178, s85, v186
    v_add_u32 v179, s85, v187
    s_cmp_lg_u32 s63, 30
    s_cbranch_scc1 L_nosc
    s_mov_b32 s84, 0
L_sc_23:
    ds_read_b32 v14, v7 offset:1064
    s_waitcnt lgkmcnt(0)
    v_readfirstlane_b32 s70, v14
    s_add_u32 s84, s84, 1
    s_cmp_ge_i32 s70, 1
    s_cbranch_scc1 L_sc_ok_24
    s_sleep 1
    s_cmp_lt_u32 s84, 0x100000
    s_cbranch_scc1 L_sc_23
L_sc_ok_24:
    v_and_b32 v5, 3, v1
    v_lshlrev_b32 v5, 2, v5
    ds_read_b32 v28, v5 offset:1280
L_nosc:
    s_mov_b64 exec, s[48:49]
    ds_read_b128 v[80:83], v188 offset:4096
    ds_read_b128 v[96:99], v188 offset:4352
    s_mov_b64 exec, s[50:51]
    ds_read_b128 v[84:87], v188 offset:4096
    ds_read_b128 v[100:103], v188 offset:4352
    s_mov_b64 exec, s[52:53]
    ds_read_b128 v[88:91], v188 offset:4096
    ds_read_b128 v[104:107], v188 offset:4352
    s_mov_b64 exec, s[54:55]
    ds_read_b128 v[92:95], v188 offset:4096
    ds_read_b128 v[108:111], v188 offset:4352
    s_mov_b64 exec, -1
    s_cmp_ge_i32 s3, s62
    s_cbranch_scc1 L_vrdy_ok_26
    s_mov_b32 s84, 0
L_vrdy_25:
    ds_read_b32 v14, v7 offset:1024
    s_waitcnt lgkmcnt(0)
    v_readfirstlane_b32 s3, v14
    s_add_u32 s84, s84, 1
    s_cmp_ge_i32 s3, s62
    s_cbranch_scc1 L_vrdy_ok_26
    s_cmp_lt_u32 s84, 0x100000
    s_cbranch_scc1 L_vrdy_25
L_vrdy_ok_26:
    ds_read_b64_tr_b16 v[48:49], v176 offset:28672
    ds_read_b64_tr_b16 v[50:51], v176 offset:32768
    ds_read_b64_tr_b16 v[52:53], v177 offset:28672
    ds_read_b64_tr_b16 v[54:55], v177 offset:32768
    ds_read_b64_tr_b16 v[56:57], v178 offset:28672
    ds_read_b64_tr_b16 v[58:59], v178 offset:32768
    ds_read_b64_tr_b16 v[60:61], v179 offset:28672
    ds_read_b64_tr_b16 v[62:63], v179 offset:32768
    s_add_u32 s62, s62, 8
    s_waitcnt lgkmcnt(6)
    v_mfma_f32_16x16x32_bf16 v[32:35], v[48:51], v[80:83], v[32:35]
    s_waitcnt lgkmcnt(4)
    v_mfma_f32_16x16x32_bf16 v[32:35], v[52:55], v[84:87], v[32:35]
    s_waitcnt lgkmcnt(2)
    v_mfma_f32_16x16x32_bf16 v[32:35], v[56:59], v[88:91], v[32:35]
    s_waitcnt lgkmcnt(0)
    v_mfma_f32_16x16x32_bf16 v[32:35], v[60:63], v[92:95], v[32:35]
    s_cmp_ge_i32 s3, s62
    s_cbranch_scc1 L_vrdy_ok_28
    s_mov_b32 s84, 0
L_vrdy_27:
    ds_read_b32 v14, v7 offset:1024
    s_waitcnt lgkmcnt(0)
    v_readfirstlane_b32 s3, v14
    s_add_u32 s84, s84, 1
    s_cmp_ge_i32 s3, s62
    s_cbranch_scc1 L_vrdy_ok_28
    s_cmp_lt_u32 s84, 0x100000
    s_cbranch_scc1 L_vrdy_27
L_vrdy_ok_28:
    ds_read_b64_tr_b16 v[64:65], v176 offset:36864
    ds_read_b64_tr_b16 v[66:67], v176 offset:40960
    ds_read_b64_tr_b16 v[68:69], v177 offset:36864
    ds_read_b64_tr_b16 v[70:71], v177 offset:40960
    ds_read_b64_tr_b16 v[72:73], v178 offset:36864
    ds_read_b64_tr_b16 v[74:75], v178 offset:40960
    ds_read_b64_tr_b16 v[76:77], v179 offset:36864
    ds_read_b64_tr_b16 v[78:79], v179 offset:40960
    s_add_u32 s62, s62, 8
    s_add_u32 s85, s85, 16384
    s_and_b32 s85, s85, 131071
    s_add_u32 s63, s63, 1
    v_add_u32 v188, 512, v188
    s_waitcnt lgkmcnt(6)
    v_mfma_f32_16x16x32_bf16 v[32:35], v[64:67], v[96:99], v[32:35]
    s_waitcnt lgkmcnt(4)
    v_mfma_f32_16x16x32_bf16 v[32:35], v[68:71], v[100:103], v[32:35]
    s_waitcnt lgkmcnt(2)
    v_mfma_f32_16x16x32_bf16 v[32:35], v[72:75], v[104:107], v[32:35]
    s_waitcnt lgkmcnt(0)
    v_mfma_f32_16x16x32_bf16 v[32:35], v[76:79], v[108:111], v[32:35]
    ds_write_b32 v30, v189 offset:1032
    v_add_u32 v189, 1, v189
    s_cmp_lt_u32 s63, 32
    s_cbranch_scc1 L_p2
    s_cmp_eq_u32 s14, 2
    s_nop 2
    v_mul_f32 v32, v32, v28
    v_mul_f32 v33, v33, v28
    v_mul_f32 v34, v34, v28
    v_mul_f32 v35, v35, v28
    v_and_or_b32 v32, v32, -16, v8
    v_and_or_b32 v33, v33, -16, v9
    v_and_or_b32 v34, v34, -16, v10
    v_and_or_b32 v35, v35, -16, v11
    s_cbranch_scc0 L_h1far
    buffer_store_dwordx4 v[32:35], v211, s[36:39], s71 offen
    s_branch L_late2
L_h1far:
    buffer_store_dwordx4 v[32:35], v211, s[36:39], s71 offen sc1
    s_branch L_late2
L_help:
    s_mov_b32 s40, s4
    s_mov_b32 s41, s5
    s_mov_b32 s42, 1024
    s_mov_b32 s43, 0x20000
    v_and_b32 v6, 3, v1
    v_lshlrev_b32 v6, 3, v6
    v_lshrrev_b32 v5, 5, v1
    v_lshl_add_u32 v6, v5, 2, v6
    s_lshl_b32 s71, s58, 5
    s_cmp_lg_u32 s57, 0
    s_cbranch_scc1 L_nox
    buffer_load_dword v58, v6, s[40:43], s71 offen
L_nox:
    s_waitcnt lgkmcnt(0)
    s_add_u32 s64, s64, 0x9E3779B1
    v_and_b32 v5, 1, v1
    v_lshlrev_b32 v5, 4, v5
    v_lshrrev_b32 v5, v5, s64
    v_bfe_u32 v8, v5, 0, 4
    v_bfe_u32 v9, v5, 4, 4
    v_bfe_u32 v10, v5, 8, 4
    v_bfe_u32 v11, v5, 12, 4
    v_and_b32 v5, 3, v1
    v_lshlrev_b32 v5, 3, v5
    v_lshrrev_b32 v5, v5, s64
    v_bfe_u32 v12, v5, 0, 4
    v_bfe_u32 v13, v5, 4, 4
    s_cmp_lg_u32 s83, 0
    s_cbranch_scc1 L_glu
    v_mov_b32 v14, 1
    ds_write_b32 v7, v14 offset:1028
    s_branch L_h3f
L_glu:
    s_and_b32 s73, s60, 3
    s_mov_b32 s84, 0
L_xn_29:
    ds_read_b32 v14, v7 offset:1044
    s_waitcnt lgkmcnt(0)
    v_readfirstlane_b32 s70, v14
    s_add_u32 s84, s84, 1
    s_cmp_ge_i32 s70, 1
    s_cbranch_scc1 L_xn_ok_30
    s_sleep 2
    s_cmp_lt_u32 s84, 0x100000
    s_cbranch_scc1 L_xn_29
L_xn_ok_30:
    s_lshl_b32 s72, s73, 8
    v_lshl_add_u32 v5, v2, 5, s72
    ds_read_b128 v[20:23], v5 offset:2048
    ds_read_b128 v[24:27], v5 offset:2064
    v_add_u32 v6, 143360, v4
    s_mov_b32 s84, 0
L_wsl_31:
    ds_read_b32 v14, v7 offset:1024
    s_waitcnt lgkmcnt(0)
    v_readfirstlane_b32 s3, v14
    s_add_u32 s84, s84, 1
    s_cmp_ge_i32 s3, 24
    s_cbranch_scc1 L_wsl_ok_32
    s_sleep 1
    s_cmp_lt_u32 s84, 0x100000
    s_cbranch_scc1 L_wsl_31
L_wsl_ok_32:
    ds_read_b128 v[64:67], v6 offset:0
    ds_read_b128 v[68:71], v6 offset:1024
    ds_read_b128 v[72:75], v6 offset:2048
    ds_read_b128 v[76:79], v6 offset:3072
    ds_read_b128 v[80:83], v6 offset:4096
    ds_read_b128 v[84:87], v6 offset:5120
    ds_read_b128 v[88:91], v6 offset:6144
    ds_read_b128 v[92:95], v6 offset:7168
    s_waitcnt lgkmcnt(0)
    v_perm_b32 v40, v68, v64, s65
    v_perm_b32 v41, v68, v64, s66
    v_perm_b32 v42, v69, v65, s65
    v_perm_b32 v43, v69, v65, s66
    v_perm_b32 v44, v70, v66, s65
    v_perm_b32 v45, v70, v66, s66
    v_perm_b32 v46, v71, v67, s65
    v_perm_b32 v47, v71, v67, s66
    v_dot2_f32_bf16 v32, v20, v40, 0
    v_dot2_f32_bf16 v33, v20, v41, 0
    v_dot2_f32_bf16 v34, v20, v42, 0
    v_dot2_f32_bf16 v35, v20, v43, 0
    v_dot2_f32_bf16 v36, v20, v44, 0
    v_dot2_f32_bf16 v37, v20, v45, 0
    v_dot2_f32_bf16 v38, v20, v46, 0
    v_dot2_f32_bf16 v39, v20, v47, 0
    v_perm_b32 v40, v76, v72, s65
    v_perm_b32 v41, v76, v72, s66
    v_perm_b32 v42, v77, v73, s65
    v_perm_b32 v43, v77, v73, s66
    v_perm_b32 v44, v78, v74, s65
    v_perm_b32 v45, v78, v74, s66
    v_perm_b32 v46, v79, v75, s65
    v_perm_b32 v47, v79, v75, s66
    v_dot2_f32_bf16 v32, v21, v40, v32
    v_dot2_f32_bf16 v33, v21, v41, v33
    v_dot2_f32_bf16 v34, v21, v42, v34
    v_dot2_f32_bf16 v35, v21, v43, v35
    v_dot2_f32_bf16 v36, v21, v44, v36
    v_dot2_f32_bf16 v37, v21, v45, v37
    v_dot2_f32_bf16 v38, v21, v46, v38
    v_dot2_f32_bf16 v39, v21, v47, v39
    v_perm_b32 v40, v84, v80, s65
    v_perm_b32 v41, v84, v80, s66
    v_perm_b32 v42, v85, v81, s65
    v_perm_b32 v43, v85, v81, s66
    v_perm_b32 v44, v86, v82, s65
    v_perm_b32 v45, v86, v82, s66
    v_perm_b32 v46, v87, v83, s65
    v_perm_b32 v47, v87, v83, s66
    v_dot2_f32_bf16 v32, v22, v40, v32
    v_dot2_f32_bf16 v33, v22, v41, v33
    v_dot2_f32_bf16 v34, v22, v42, v34
    v_dot2_f32_bf16 v35, v22, v43, v35
    v_dot2_f32_bf16 v36, v22, v44, v36
    v_dot2_f32_bf16 v37, v22, v45, v37
    v_dot2_f32_bf16 v38, v22, v46, v38
    v_dot2_f32_bf16 v39, v22, v47, v39
    v_perm_b32 v40, v92, v88, s65
    v_perm_b32 v41, v92, v88, s66
    v_perm_b32 v42, v93, v89, s65
    v_perm_b32 v43, v93, v89, s66
    v_perm_b32 v44, v94, v90, s65
    v_perm_b32 v45, v94, v90, s66
    v_perm_b32 v46, v95, v91, s65
    v_perm_b32 v47, v95, v91, s66
    v_dot2_f32_bf16 v32, v23, v40, v32
    v_dot2_f32_bf16 v33, v23, v41, v33
    v_dot2_f32_bf16 v34, v23, v42, v34
    v_dot2_f32_bf16 v35, v23, v43, v35
    v_dot2_f32_bf16 v36, v23, v44, v36
    v_dot2_f32_bf16 v37, v23, v45, v37
    v_dot2_f32_bf16 v38, v23, v46, v38
    v_dot2_f32_bf16 v39, v23, v47, v39
    s_nop 2
    s_mov_b32 s84, 0
L_wsl_33:
    ds_read_b32 v14, v7 offset:1024
    s_waitcnt lgkmcnt(0)
    v_readfirstlane_b32 s3, v14
    s_add_u32 s84, s84, 1
    s_cmp_ge_i32 s3, 32
    s_cbranch_scc1 L_wsl_ok_34
    s_sleep 1
    s_cmp_lt_u32 s84, 0x100000
    s_cbranch_scc1 L_wsl_33
L_wsl_ok_34:
    ds_read_b128 v[64:67], v6 offset:8192
    ds_read_b128 v[68:71], v6 offset:9216
    ds_read_b128 v[72:75], v6 offset:10240
    ds_read_b128 v[76:79], v6 offset:11264
    ds_read_b128 v[80:83], v6 offset:12288
    ds_read_b128 v[84:87], v6 offset:13312
    ds_read_b128 v[88:91], v6 offset:14336
    ds_read_b128 v[92:95], v6 offset:15360
    s_waitcnt lgkmcnt(0)
    v_mov_b32 v14, 1
    ds_write_b32 v7, v14 offset:1028
    v_perm_b32 v40, v68, v64, s65
    v_perm_b32 v41, v68, v64, s66
    v_perm_b32 v42, v69, v65, s65
    v_perm_b32 v43, v69, v65, s66
    v_perm_b32 v44, v70, v66, s65
    v_perm_b32 v45, v70, v66, s66
    v_perm_b32 v46, v71, v67, s65
    v_perm_b32 v47, v71, v67, s66
    v_dot2_f32_bf16 v32, v24, v40, v32
    v_dot2_f32_bf16 v33, v24, v41, v33
    v_dot2_f32_bf16 v34, v24, v42, v34
    v_dot2_f32_bf16 v35, v24, v43, v35
    v_dot2_f32_bf16 v36, v24, v44, v36
    v_dot2_f32_bf16 v37, v24, v45, v37
    v_dot2_f32_bf16 v38, v24, v46, v38
    v_dot2_f32_bf16 v39, v24, v47, v39
    v_perm_b32 v40, v76, v72, s65
    v_perm_b32 v41, v76, v72, s66
    v_perm_b32 v42, v77, v73, s65
    v_perm_b32 v43, v77, v73, s66
    v_perm_b32 v44, v78, v74, s65
    v_perm_b32 v45, v78, v74, s66
    v_perm_b32 v46, v79, v75, s65
    v_perm_b32 v47, v79, v75, s66
    v_dot2_f32_bf16 v32, v25, v40, v32
    v_dot2_f32_bf16 v33, v25, v41, v33
    v_dot2_f32_bf16 v34, v25, v42, v34
    v_dot2_f32_bf16 v35, v25, v43, v35
    v_dot2_f32_bf16 v36, v25, v44, v36
    v_dot2_f32_bf16 v37, v25, v45, v37
    v_dot2_f32_bf16 v38, v25, v46, v38
    v_dot2_f32_bf16 v39, v25, v47, v39
    v_perm_b32 v40, v84, v80, s65
    v_perm_b32 v41, v84, v80, s66
    v_perm_b32 v42, v85, v81, s65
    v_perm_b32 v43, v85, v81, s66
    v_perm_b32 v44, v86, v82, s65
    v_perm_b32 v45, v86, v82, s66
    v_perm_b32 v46, v87, v83, s65
    v_perm_b32 v47, v87, v83, s66
    v_dot2_f32_bf16 v32, v26, v40, v32
    v_dot2_f32_bf16 v33, v26, v41, v33
    v_dot2_f32_bf16 v34, v26, v42, v34
    v_dot2_f32_bf16 v35, v26, v43, v35
    v_dot2_f32_bf16 v36, v26, v44, v36
    v_dot2_f32_bf16 v37, v26, v45, v37
    v_dot2_f32_bf16 v38, v26, v46, v38
    v_dot2_f32_bf16 v39, v26, v47, v39
    v_perm_b32 v40, v92, v88, s65
    v_perm_b32 v41, v92, v88, s66
    v_perm_b32 v42, v93, v89, s65
    v_perm_b32 v43, v93, v89, s66
    v_perm_b32 v44, v94, v90, s65
    v_perm_b32 v45, v94, v90, s66
    v_perm_b32 v46, v95, v91, s65
    v_perm_b32 v47, v95, v91, s66
    v_dot2_f32_bf16 v32, v27, v40, v32
    v_dot2_f32_bf16 v33, v27, v41, v33
    v_dot2_f32_bf16 v34, v27, v42, v34
    v_dot2_f32_bf16 v35, v27, v43, v35
    v_dot2_f32_bf16 v36, v27, v44, v36
    v_dot2_f32_bf16 v37, v27, v45, v37
    v_dot2_f32_bf16 v38, v27, v46, v38
    v_dot2_f32_bf16 v39, v27, v47, v39
    s_nop 2
    s_nop 1
    v_permlane32_swap_b32 v32, v36
    v_permlane32_swap_b32 v33, v37
    v_permlane32_swap_b32 v34, v38
    v_permlane32_swap_b32 v35, v39
    s_nop 1
    v_add_f32 v32, v32, v36
    v_add_f32 v33, v33, v37
    v_add_f32 v34, v34, v38
    v_add_f32 v35, v35, v39
    s_nop 1
    v_permlane16_swap_b32 v32, v34
    v_permlane16_swap_b32 v33, v35
    s_nop 1
    v_add_f32 v32, v32, v34
    v_add_f32 v33, v33, v35
    s_nop 0
    v_add_f32 v32, v32, v32 row_ror:8
    v_add_f32 v33, v33, v33 row_ror:8
    s_nop 0
    v_lshrrev_b32 v6, 4, v1
    v_lshlrev_b32 v6, 6, v6
    v_lshrrev_b32 v5, 1, v3
    v_add_u32 v6, v6, v5
    v_and_or_b32 v32, v32, -16, v12
    v_and_or_b32 v33, v33, -16, v13
    s_mov_b32 s84, 0
L_qh3_35:
    ds_read_b32 v14, v7 offset:1040
    s_waitcnt lgkmcnt(0)
    v_readfirstlane_b32 s14, v14
    s_add_u32 s84, s84, 1
    s_cmp_ge_i32 s14, 1
    s_cbranch_scc1 L_qh3_ok_36
    s_sleep 4
    s_cmp_lt_u32 s84, 0x100000
    s_cbranch_scc1 L_qh3_35
L_qh3_ok_36:
    s_lshl_b32 s71, s58, 8
    s_add_u32 s71, s71, s0
    s_add_u32 s71, s71, 73728
    s_and_b32 s70, s71, 0xfffff800
    s_mov_b32 exec_lo, 0x00ff00ff
    s_mov_b32 exec_hi, 0x00ff00ff
    s_cmp_eq_u32 s14, 2
    s_cbranch_scc0 L_far_37
    buffer_store_dwordx2 v[32:33], v6, s[36:39], s71 offen
    s_branch L_st_38
L_far_37:
    buffer_store_dwordx2 v[32:33], v6, s[36:39], s71 offen sc1
L_st_38:
    s_mov_b64 exec, -1
    s_mov_b32 s84, 0
L_g2gate_39:
    ds_read_b32 v14, v7 offset:1024
    s_waitcnt lgkmcnt(0)
    v_readfirstlane_b32 s3, v14
    s_add_u32 s84, s84, 1
    s_cmp_ge_i32 s3, 192
    s_cbranch_scc1 L_g2gate_ok_40
    s_sleep 16
    s_cmp_lt_u32 s84, 0x100000
    s_cbranch_scc1 L_g2gate_39
L_g2gate_ok_40:
    ds_read_b128 v[64:67], v4 offset:20480
    ds_read_b128 v[68:71], v4 offset:21504
    ds_read_b128 v[72:75], v4 offset:22528
    ds_read_b128 v[76:79], v4 offset:23552
    ds_read_b128 v[80:83], v4 offset:24576
    ds_read_b128 v[84:87], v4 offset:25600
    ds_read_b128 v[88:91], v4 offset:26624
    ds_read_b128 v[92:95], v4 offset:27648
    s_mov_b32 s84, 0
L_g1poll_41:
    buffer_load_dwordx4 v[32:35], v4, s[36:39], s70 offen offset:0 sc1
    buffer_load_dwordx4 v[36:39], v4, s[36:39], s70 offen offset:1024 sc1
    s_waitcnt vmcnt(0)
    v_xor_b32 v32, v8, v32
    v_xor_b32 v33, v9, v33
    v_xor_b32 v34, v10, v34
    v_xor_b32 v35, v11, v35
    v_xor_b32 v36, v8, v36
    v_xor_b32 v37, v9, v37
    v_xor_b32 v38, v10, v38
    v_xor_b32 v39, v11, v39
    v_or_b32 v14, v32, v33
    v_or3_b32 v14, v14, v34, v35
    v_or3_b32 v14, v14, v36, v37
    v_or3_b32 v14, v14, v38, v39
    v_and_b32 v14, 15, v14
    v_cmp_ne_u32 vcc, 0, v14
    s_cbranch_vccz L_g1poll_ok_42
    s_sleep 32
    s_add_u32 s84, s84, 1
    s_cmp_lt_u32 s84, s15
    s_cbranch_scc1 L_g1poll_41
L_g1poll_ok_42:
    v_mov_b32 v14, v32
    s_nop 1
    v_permlane16_swap_b32 v32, v14
    s_nop 1
    v_add_f32 v32, v32, v14
    v_mov_b32 v14, v32
    s_nop 1
    v_permlane32_swap_b32 v32, v14
    s_nop 1
    v_add_f32 v32, v32, v14
    v_cvt_pk_bf16_f32 v32, v32, v32
    v_and_b32 v32, 0xffff0000, v32
    v_mov_b32 v14, v33
    s_nop 1
    v_permlane16_swap_b32 v33, v14
    s_nop 1
    v_add_f32 v33, v33, v14
    v_mov_b32 v14, v33
    s_nop 1
    v_permlane32_swap_b32 v33, v14
    s_nop 1
    v_add_f32 v33, v33, v14
    v_cvt_pk_bf16_f32 v33, v33, v33
    v_and_b32 v33, 0xffff0000, v33
    v_mov_b32 v14, v34
    s_nop 1
    v_permlane16_swap_b32 v34, v14
    s_nop 1
    v_add_f32 v34, v34, v14
    v_mov_b32 v14, v34
    s_nop 1
    v_permlane32_swap_b32 v34, v14
    s_nop 1
    v_add_f32 v34, v34, v14
    v_cvt_pk_bf16_f32 v34, v34, v34
    v_and_b32 v34, 0xffff0000, v34
    v_mov_b32 v14, v35
    s_nop 1
    v_permlane16_swap_b32 v35, v14
    s_nop 1
    v_add_f32 v35, v35, v14
    v_mov_b32 v14, v35
    s_nop 1
    v_permlane32_swap_b32 v35, v14
    s_nop 1
    v_add_f32 v35, v35, v14
    v_cvt_pk_bf16_f32 v35, v35, v35
    v_and_b32 v35, 0xffff0000, v35
    v_mov_b32 v14, v36
    s_nop 1
    v_permlane16_swap_b32 v36, v14
    s_nop 1
    v_add_f32 v36, v36, v14
    v_mov_b32 v14, v36
    s_nop 1
    v_permlane32_swap_b32 v36, v14
    s_nop 1
    v_add_f32 v36, v36, v14
    v_cvt_pk_bf16_f32 v36, v36, v36
    v_and_b32 v36, 0xffff0000, v36
    v_mov_b32 v14, v37
    s_nop 1
    v_permlane16_swap_b32 v37, v14
    s_nop 1
    v_add_f32 v37, v37, v14
    v_mov_b32 v14, v37
    s_nop 1
    v_permlane32_swap_b32 v37, v14
    s_nop 1
    v_add_f32 v37, v37, v14
    v_cvt_pk_bf16_f32 v37, v37, v37
    v_and_b32 v37, 0xffff0000, v37
    v_mov_b32 v14, v38
    s_nop 1
    v_permlane16_swap_b32 v38, v14
    s_nop 1
    v_add_f32 v38, v38, v14
    v_mov_b32 v14, v38
    s_nop 1
    v_permlane32_swap_b32 v38, v14
    s_nop 1
    v_add_f32 v38, v38, v14
    v_cvt_pk_bf16_f32 v38, v38, v38
    v_and_b32 v38, 0xffff0000, v38
    v_mov_b32 v14, v39
    s_nop 1
    v_permlane16_swap_b32 v39, v14
    s_nop 1
    v_add_f32 v39, v39, v14
    v_mov_b32 v14, v39
    s_nop 1
    v_permlane32_swap_b32 v39, v14
    s_nop 1
    v_add_f32 v39, v39, v14
    v_cvt_pk_bf16_f32 v39, v39, v39
    v_and_b32 v39, 0xffff0000, v39
    v_mul_f32 v32, s68, v32
    v_exp_f32 v32, -v32
    s_nop 0
    v_add_f32 v32, 1.0, v32
    v_rcp_f32 v32, v32
    s_nop 0
    v_cvt_pk_bf16_f32 v32, v32, v32
    v_and_b32 v32, 0xffff0000, v32
    v_mul_f32 v32, v32, v36
    v_mul_f32 v33, s68, v33
    v_exp_f32 v33, -v33
    s_nop 0
    v_add_f32 v33, 1.0, v33
    v_rcp_f32 v33, v33
    s_nop 0
    v_cvt_pk_bf16_f32 v33, v33, v33
    v_and_b32 v33, 0xffff0000, v33
    v_mul_f32 v33, v33, v37
    v_mul_f32 v34, s68, v34
    v_exp_f32 v34, -v34
    s_nop 0
    v_add_f32 v34, 1.0, v34
    v_rcp_f32 v34, v34
    s_nop 0
    v_cvt_pk_bf16_f32 v34, v34, v34
    v_and_b32 v34, 0xffff0000, v34
    v_mul_f32 v34, v34, v38
    v_mul_f32 v35, s68, v35
    v_exp_f32 v35, -v35
    s_nop 0
    v_add_f32 v35, 1.0, v35
    v_rcp_f32 v35, v35
    s_nop 0
    v_cvt_pk_bf16_f32 v35, v35, v35
    v_and_b32 v35, 0xffff0000, v35
    v_mul_f32 v35, v35, v39
    v_cvt_pk_bf16_f32 v32, v32, v33
    v_cvt_pk_bf16_f32 v33, v34, v35
    v_and_b32 v5, 3, v1
    v_lshlrev_b32 v5, 5, v5
    v_and_b32 v6, 12, v1
    v_add_u32 v5, v5, v6
    v_lshlrev_b32 v6, 4, v2
    ds_write_b32 v5, v32 offset:1536
    ds_write_b32 v5, v33 offset:1552
    ds_read_b128 v[20:23], v6 offset:1536
    s_waitcnt lgkmcnt(0)
    v_perm_b32 v40, v68, v64, s65
    v_perm_b32 v41, v68, v64, s66
    v_perm_b32 v42, v69, v65, s65
    v_perm_b32 v43, v69, v65, s66
    v_perm_b32 v44, v70, v66, s65
    v_perm_b32 v45, v70, v66, s66
    v_perm_b32 v46, v71, v67, s65
    v_perm_b32 v47, v71, v67, s66
    v_dot2_f32_bf16 v32, v20, v40, 0
    v_dot2_f32_bf16 v33, v20, v41, 0
    v_dot2_f32_bf16 v34, v20, v42, 0
    v_dot2_f32_bf16 v35, v20, v43, 0
    v_dot2_f32_bf16 v36, v20, v44, 0
    v_dot2_f32_bf16 v37, v20, v45, 0
    v_dot2_f32_bf16 v38, v20, v46, 0
    v_dot2_f32_bf16 v39, v20, v47, 0
    v_perm_b32 v40, v76, v72, s65
    v_perm_b32 v41, v76, v72, s66
    v_perm_b32 v42, v77, v73, s65
    v_perm_b32 v43, v77, v73, s66
    v_perm_b32 v44, v78, v74, s65
    v_perm_b32 v45, v78, v74, s66
    v_perm_b32 v46, v79, v75, s65
    v_perm_b32 v47, v79, v75, s66
    v_dot2_f32_bf16 v32, v21, v40, v32
    v_dot2_f32_bf16 v33, v21, v41, v33
    v_dot2_f32_bf16 v34, v21, v42, v34
    v_dot2_f32_bf16 v35, v21, v43, v35
    v_dot2_f32_bf16 v36, v21, v44, v36
    v_dot2_f32_bf16 v37, v21, v45, v37
    v_dot2_f32_bf16 v38, v21, v46, v38
    v_dot2_f32_bf16 v39, v21, v47, v39
    v_perm_b32 v40, v84, v80, s65
    v_perm_b32 v41, v84, v80, s66
    v_perm_b32 v42, v85, v81, s65
    v_perm_b32 v43, v85, v81, s66
    v_perm_b32 v44, v86, v82, s65
    v_perm_b32 v45, v86, v82, s66
    v_perm_b32 v46, v87, v83, s65
    v_perm_b32 v47, v87, v83, s66
    v_dot2_f32_bf16 v32, v22, v40, v32
    v_dot2_f32_bf16 v33, v22, v41, v33
    v_dot2_f32_bf16 v34, v22, v42, v34
    v_dot2_f32_bf16 v35, v22, v43, v35
    v_dot2_f32_bf16 v36, v22, v44, v36
    v_dot2_f32_bf16 v37, v22, v45, v37
    v_dot2_f32_bf16 v38, v22, v46, v38
    v_dot2_f32_bf16 v39, v22, v47, v39
    v_perm_b32 v40, v92, v88, s65
    v_perm_b32 v41, v92, v88, s66
    v_perm_b32 v42, v93, v89, s65
    v_perm_b32 v43, v93, v89, s66
    v_perm_b32 v44, v94, v90, s65
    v_perm_b32 v45, v94, v90, s66
    v_perm_b32 v46, v95, v91, s65
    v_perm_b32 v47, v95, v91, s66
    v_dot2_f32_bf16 v32, v23, v40, v32
    v_dot2_f32_bf16 v33, v23, v41, v33
    v_dot2_f32_bf16 v34, v23, v42, v34
    v_dot2_f32_bf16 v35, v23, v43, v35
    v_dot2_f32_bf16 v36, v23, v44, v36
    v_dot2_f32_bf16 v37, v23, v45, v37
    v_dot2_f32_bf16 v38, v23, v46, v38
    v_dot2_f32_bf16 v39, v23, v47, v39
    s_nop 2
    s_nop 1
    v_permlane32_swap_b32 v32, v36
    v_permlane32_swap_b32 v33, v37
    v_permlane32_swap_b32 v34, v38
    v_permlane32_swap_b32 v35, v39
    s_nop 1
    v_add_f32 v32, v32, v36
    v_add_f32 v33, v33, v37
    v_add_f32 v34, v34, v38
    v_add_f32 v35, v35, v39
    s_nop 1
    v_permlane16_swap_b32 v32, v34
    v_permlane16_swap_b32 v33, v35
    s_nop 1
    v_add_f32 v32, v32, v34
    v_add_f32 v33, v33, v35
    s_nop 0
    v_add_f32 v32, v32, v32 row_ror:8
    v_add_f32 v33, v33, v33 row_ror:8
    s_nop 0
    v_lshrrev_b32 v6, 4, v1
    v_lshlrev_b32 v6, 3, v6
    v_lshl_add_u32 v6, v3, 1, v6
    v_lshlrev_b32 v5, 2, v1
    ds_write_b64 v6, v[32:33] offset:1536
    ds_read_b32 v32, v5 offset:1536
    v_and_b32 v5, 7, v1
    v_lshlrev_b32 v5, 2, v5
    v_lshrrev_b32 v33, v5, s64
    v_and_b32 v33, 15, v33
    v_lshrrev_b32 v6, 4, v1
    v_lshlrev_b32 v6, 11, v6
    v_and_b32 v5, 15, v1
    v_lshl_add_u32 v6, v5, 2, v6
    s_lshl_b32 s71, s60, 13
    s_lshl_b32 s72, s59, 6
    s_add_u32 s71, s71, s72
    s_add_u32 s71, s71, 1048576
    s_waitcnt lgkmcnt(0)
    v_and_or_b32 v32, v32, -16, v33
    buffer_store_dword v32, v6, s[36:39], s71 offen sc1
L_h3f:
    s_cmp_lg_u32 s57, 0
    s_cbranch_scc1 L_hstat
    s_mov_b32 s84, 0
L_g3gate_43:
    ds_read_b32 v14, v7 offset:1024
    s_waitcnt lgkmcnt(0)
    v_readfirstlane_b32 s3, v14
    s_add_u32 s84, s84, 1
    s_cmp_ge_i32 s3, 384
    s_cbranch_scc1 L_g3gate_ok_44
    s_sleep 16
    s_cmp_lt_u32 s84, 0x100000
    s_cbranch_scc1 L_g3gate_43
L_g3gate_ok_44:
    s_lshl_b32 s74, s58, 11
    s_add_u32 s74, s74, 1048576
    v_min_u32 v6, 47, v1
    v_and_b32 v6, 60, v6
    v_and_b32 v5, 3, v1
    v_or_b32 v6, v6, v5
    v_lshlrev_b32 v6, 4, v6
    s_mov_b32 s84, 0
L_gpoll_45:
    buffer_load_dwordx4 v[64:67], v4, s[36:39], s74 offen sc1
    buffer_load_dwordx4 v[68:71], v6, s[36:39], s74 offen offset:1024 sc1
    s_waitcnt vmcnt(0)
    v_xor_b32 v64, v8, v64
    v_xor_b32 v65, v9, v65
    v_xor_b32 v66, v10, v66
    v_xor_b32 v67, v11, v67
    v_xor_b32 v68, v8, v68
    v_xor_b32 v69, v9, v69
    v_xor_b32 v70, v10, v70
    v_xor_b32 v71, v11, v71
    v_or_b32 v14, v64, v65
    v_or3_b32 v14, v14, v66, v67
    v_or3_b32 v14, v14, v68, v69
    v_or3_b32 v14, v14, v70, v71
    v_and_b32 v14, 15, v14
    v_cmp_ne_u32 vcc, 0, v14
    s_cbranch_vccz L_gpoll_ok_46
    s_sleep 64
    s_add_u32 s84, s84, 1
    s_cmp_lt_u32 s84, s15
    s_cbranch_scc1 L_gpoll_45
L_gpoll_ok_46:
    s_mov_b32 exec_hi, 0xffff
    v_add_f32 v64, v64, v68
    v_add_f32 v65, v65, v69
    v_add_f32 v66, v66, v70
    v_add_f32 v67, v67, v71
    s_mov_b64 exec, -1
    s_nop 1
    v_permlane32_swap_b32 v64, v66
    v_permlane32_swap_b32 v65, v67
    s_nop 0
    v_add_f32 v64, v64, v66
    v_add_f32 v65, v65, v67
    s_nop 0
    v_add_f32 v64, v64, v64 row_ror:8
    v_add_f32 v65, v65, v65 row_ror:8
    s_nop 0
    v_add_f32 v64, v64, v64 row_ror:4
    v_add_f32 v65, v65, v65 row_ror:4
    v_mov_b32 v66, v64
    v_mov_b32 v67, v65
    s_nop 0
    v_permlane16_swap_b32 v64, v66
    v_permlane16_swap_b32 v65, v67
    s_nop 0
    v_add_f32 v64, v64, v66
    v_add_f32 v65, v65, v67
    v_cvt_pk_bf16_f32 v64, v64, v64
    v_and_b32 v64, 0xffff0000, v64
    v_mul_f32 v68, s68, v64
    v_exp_f32 v68, -v68
    s_nop 0
    v_add_f32 v68, 1.0, v68
    v_rcp_f32 v68, v68
    s_nop 0
    v_mul_f32 v56, v64, v68
    v_cvt_pk_bf16_f32 v56, v56, v56
    v_and_b32 v56, 0xffff0000, v56
    v_cvt_pk_bf16_f32 v65, v65, v65
    v_and_b32 v65, 0xffff0000, v65
    v_mul_f32 v68, s68, v65
    v_exp_f32 v68, -v68
    s_nop 0
    v_add_f32 v68, 1.0, v68
    v_rcp_f32 v68, v68
    s_nop 0
    v_mul_f32 v57, v65, v68
    v_cvt_pk_bf16_f32 v57, v57, v57
    v_and_b32 v57, 0xffff0000, v57
L_hstat:
    s_mov_b32 s84, 0
L_pdh_47:
    ds_read_b64 v[14:15], v7 offset:1056
    s_waitcnt lgkmcnt(0)
    v_min_i32 v14, v14, v15
    s_nop 0
    v_readfirstlane_b32 s70, v14
    s_add_u32 s84, s84, 1
    s_cmp_ge_i32 s70, 1
    s_cbranch_scc1 L_pdh_ok_48
    s_sleep 16
    s_cmp_lt_u32 s84, 0x100000
    s_cbranch_scc1 L_pdh_47
L_pdh_ok_48:
    s_mov_b32 s84, 0
L_tg_49:
    ds_read_b32 v14, v7 offset:1072
    s_waitcnt lgkmcnt(0)
    v_readfirstlane_b32 s70, v14
    s_add_u32 s84, s84, 1
    s_cmp_ge_i32 s70, 1
    s_cbranch_scc1 L_tg_ok_50
    s_sleep 4
    s_cmp_lt_u32 s84, 0x100000
    s_cbranch_scc1 L_tg_49
L_tg_ok_50:
    s_mov_b32 s84, 0
L_qh4_51:
    ds_read_b32 v14, v7 offset:1040
    s_waitcnt lgkmcnt(0)
    v_readfirstlane_b32 s14, v14
    s_add_u32 s84, s84, 1
    s_cmp_ge_i32 s14, 1
    s_cbranch_scc1 L_qh4_ok_52
    s_sleep 4
    s_cmp_lt_u32 s84, 0x100000
    s_cbranch_scc1 L_qh4_51
L_qh4_ok_52:
    v_and_b32 v5, 3, v1
    v_lshlrev_b32 v5, 3, v5
    ds_read_b64 v[32:33], v5 offset:1216
    ds_read_b32 v34, v5 offset:1248
    s_waitcnt lgkmcnt(0)
    v_add_f32 v32, v32, v34
    v_log_f32 v32, v32
    v_mov_b32 v35, s64
    v_add_f32 v34, v32, v33
    s_add_u32 s70, s0, 81920
    s_lshl_b32 s71, s58, 5
    s_add_u32 s71, s71, s70
    s_mov_b64 exec, 15
    s_cmp_eq_u32 s14, 2
    s_cbranch_scc0 L_far_53
    buffer_store_dwordx2 v[34:35], v5, s[36:39], s71 offen
    s_branch L_st_54
L_far_53:
    buffer_store_dwordx2 v[34:35], v5, s[36:39], s71 offen sc1
L_st_54:
    s_mov_b64 exec, -1
    s_mov_b32 s84, 0
L_lsgate_55:
    ds_read_b32 v14, v7 offset:1024
    s_waitcnt lgkmcnt(0)
    v_readfirstlane_b32 s3, v14
    s_add_u32 s84, s84, 1
    s_cmp_ge_i32 s3, 800
    s_cbranch_scc1 L_lsgate_ok_56
    s_sleep 16
    s_cmp_lt_u32 s84, 0x100000
    s_cbranch_scc1 L_lsgate_55
L_lsgate_ok_56:
    v_lshlrev_b32 v6, 3, v1
    s_mov_b32 s84, 0
L_lspoll_57:
    buffer_load_dwordx2 v[36:37], v6, s[36:39], s70 offen offset:0 sc1
    buffer_load_dwordx2 v[38:39], v6, s[36:39], s70 offen offset:512 sc1
    s_waitcnt vmcnt(0)
    v_xor_b32 v14, s64, v37
    v_bitop3_b32 v14, v14, v39, s64 bitop3:0xf6
    v_cmp_ne_u32 vcc, 0, v14
    s_cbranch_vccz L_lspoll_ok_58
    s_sleep 16
    s_add_u32 s84, s84, 1
    s_cmp_lt_u32 s84, s15
    s_cbranch_scc1 L_lspoll_57
L_lspoll_ok_58:
    v_max_f32 v40, v36, v38
    s_nop 1
    v_max_f32 v40, v40, v40 row_ror:8
    s_nop 1
    v_max_f32 v40, v40, v40 row_ror:4
    v_mov_b32 v14, v40
    s_nop 1
    v_permlane16_swap_b32 v40, v14
    s_nop 1
    v_max_f32 v40, v40, v14
    v_mov_b32 v14, v40
    s_nop 1
    v_permlane32_swap_b32 v40, v14
    s_nop 1
    v_max_f32 v40, v40, v14
    v_sub_f32 v36, v36, v40
    v_sub_f32 v38, v38, v40
    v_exp_f32 v36, v36
    v_exp_f32 v38, v38
    v_sub_f32 v33, v33, v40
    v_add_f32 v36, v36, v38
    s_nop 1
    v_add_f32 v36, v36, v36 row_ror:8
    s_nop 1
    v_add_f32 v36, v36, v36 row_ror:4
    v_mov_b32 v14, v36
    s_nop 1
    v_permlane16_swap_b32 v36, v14
    s_nop 1
    v_add_f32 v36, v36, v14
    v_mov_b32 v14, v36
    s_nop 1
    v_permlane32_swap_b32 v36, v14
    s_nop 1
    v_add_f32 v36, v36, v14
    v_exp_f32 v33, v33
    v_rcp_f32 v36, v36
    v_lshrrev_b32 v5, 1, v5
    v_mul_f32 v33, v33, v36
    ds_write_b32 v5, v33 offset:1280
    v_mov_b32 v14, 1
    ds_write_b32 v7, v14 offset:1064
    v_bfe_u32 v5, v1, 2, 3
    v_lshlrev_b32 v5, 7, v5
    v_lshrrev_b32 v6, 5, v1
    v_lshl_add_u32 v5, v6, 17, v5
    v_and_b32 v215, 3, v1
    v_lshl_add_u32 v214, v215, 4, v5
    v_lshl_add_u32 v215, v215, 1, v6
    v_lshlrev_b32 v215, 2, v215
    v_bfe_u32 v5, v1, 2, 2
    v_mul_u32_u24 v5, 0x140, v5
    v_lshrrev_b32 v6, 4, v1
    v_lshlrev_b32 v6, 5, v6
    v_xor_b32 v5, v5, v6
    v_and_b32 v6, 3, v1
    v_lshl_add_u32 v5, v6, 3, v5
    s_lshl_b32 s72, s82, 12
    v_add_u32 v212, s72, v5
    v_xor_b32 v213, 0x80, v212
    s_and_b32 s72, s58, 28
    s_add_u32 s72, s72, s82
    s_lshl_b32 s72, s72, 11
    s_add_u32 s24, s0, s72
    s_lshl_b32 s72, s82, 9
    s_add_u32 s72, s72, 2048
    v_lshl_add_u32 v208, v1, 2, s72
    v_lshlrev_b32 v209, 3, v1
    v_and_b32 v5, 15, v1
    v_lshlrev_b32 v5, 3, v5
    v_lshrrev_b32 v6, 4, v1
    v_lshl_add_u32 v210, v6, 10, v5
    s_and_b32 s25, s58, 3
    s_lshl_b32 s25, s25, 12
    s_add_u32 s25, s25, s0
    s_lshr_b32 s72, s58, 2
    s_lshl_b32 s72, s72, 7
    s_add_u32 s25, s25, s72
    s_add_u32 s25, s25, 86016
L_late:
    s_mov_b32 s84, 0
L_late_59:
    ds_read_b32 v14, v7 offset:1024
    s_waitcnt lgkmcnt(0)
    v_readfirstlane_b32 s3, v14
    s_add_u32 s84, s84, 1
    s_cmp_ge_i32 s3, 1048
    s_cbranch_scc1 L_late_ok_60
    s_sleep 4
    s_cmp_lt_u32 s84, 0x100000
    s_cbranch_scc1 L_late_59
L_late_ok_60:
L_late2:
    s_mov_b32 s84, 0
L_late2_61:
    ds_read_b32 v14, v7 offset:1024
    s_waitcnt lgkmcnt(0)
    v_readfirstlane_b32 s3, v14
    s_add_u32 s84, s84, 1
    s_cmp_ge_i32 s3, 1076
    s_cbranch_scc1 L_late2_ok_62
    s_cmp_lt_u32 s84, 0x100000
    s_cbranch_scc1 L_late2_61
L_late2_ok_62:
L_tail:
    buffer_load_dwordx4 v[144:147], v4, s[36:39], s24 offen offset:0 sc1
    buffer_load_dwordx4 v[148:151], v4, s[36:39], s24 offen offset:1024 sc1
    s_cmp_ge_i32 s3, 1080
    s_cbranch_scc1 L_wordy_ok_64
    s_mov_b32 s84, 0
L_wordy_63:
    ds_read_b32 v14, v7 offset:1024
    s_waitcnt lgkmcnt(0)
    v_readfirstlane_b32 s3, v14
    s_add_u32 s84, s84, 1
    s_cmp_ge_i32 s3, 1080
    s_cbranch_scc1 L_wordy_ok_64
    s_cmp_lt_u32 s84, 0x100000
    s_cbranch_scc1 L_wordy_63
L_wordy_ok_64:
    buffer_load_dwordx4 v[152:155], v4, s[36:39], s24 offen offset:0 sc1
    buffer_load_dwordx4 v[156:159], v4, s[36:39], s24 offen offset:1024 sc1
    ds_read_b64_tr_b16 v[192:193], v212 offset:28672
    ds_read_b64_tr_b16 v[194:195], v213 offset:28672
    ds_read_b64_tr_b16 v[196:197], v212 offset:29696
    ds_read_b64_tr_b16 v[198:199], v213 offset:29696
    ds_read_b64_tr_b16 v[200:201], v212 offset:30720
    ds_read_b64_tr_b16 v[202:203], v213 offset:30720
    ds_read_b64_tr_b16 v[204:205], v212 offset:31744
    ds_read_b64_tr_b16 v[206:207], v213 offset:31744
    s_mov_b32 s84, 0
    s_waitcnt vmcnt(2)
    v_xor_b32 v144, v8, v144
    v_xor_b32 v145, v9, v145
    v_xor_b32 v146, v10, v146
    v_xor_b32 v147, v11, v147
    v_xor_b32 v148, v8, v148
    v_xor_b32 v149, v9, v149
    v_xor_b32 v150, v10, v150
    v_xor_b32 v151, v11, v151
    v_or_b32 v14, v144, v145
    v_or3_b32 v14, v14, v146, v147
    v_or3_b32 v14, v14, v148, v149
    v_or3_b32 v14, v14, v150, v151
    v_and_b32 v14, 15, v14
    v_cmp_ne_u32 vcc, 0, v14
    v_pk_add_f32 v[40:41], v[144:145], v[148:149]
    v_pk_add_f32 v[42:43], v[146:147], v[150:151]
    s_cbranch_vccz L_h1ok
L_h1poll:
    s_waitcnt vmcnt(0)
    v_xor_b32 v152, v8, v152
    v_xor_b32 v153, v9, v153
    v_xor_b32 v154, v10, v154
    v_xor_b32 v155, v11, v155
    v_xor_b32 v156, v8, v156
    v_xor_b32 v157, v9, v157
    v_xor_b32 v158, v10, v158
    v_xor_b32 v159, v11, v159
    v_or_b32 v14, v152, v153
    v_or3_b32 v14, v14, v154, v155
    v_or3_b32 v14, v14, v156, v157
    v_or3_b32 v14, v14, v158, v159
    v_and_b32 v14, 15, v14
    v_cmp_ne_u32 vcc, 0, v14
    v_pk_add_f32 v[40:41], v[152:153], v[156:157]
    v_pk_add_f32 v[42:43], v[154:155], v[158:159]
    s_cbranch_vccz L_h1ok
    buffer_load_dwordx4 v[152:155], v4, s[36:39], s24 offen offset:0 sc1
    buffer_load_dwordx4 v[156:159], v4, s[36:39], s24 offen offset:1024 sc1
    s_add_u32 s84, s84, 1
    s_cmp_lt_u32 s84, s15
    s_cbranch_scc1 L_h1poll
L_h1ok:
    s_nop 1
    v_permlane32_swap_b32 v40, v42
    v_permlane32_swap_b32 v41, v43
    s_nop 0
    v_add_f32 v40, v40, v42
    v_add_f32 v41, v41, v43
    s_nop 0
    v_add_f32 v40, v40, v40 row_ror:8
    v_add_f32 v41, v41, v41 row_ror:8
    s_nop 0
    v_add_f32 v40, v40, v40 row_ror:4
    v_add_f32 v41, v41, v41 row_ror:4
    v_mov_b32 v42, v40
    v_mov_b32 v43, v41
    s_nop 0
    v_permlane16_swap_b32 v40, v42
    v_permlane16_swap_b32 v41, v43
    s_nop 0
    v_add_f32 v40, v40, v42
    v_add_f32 v41, v41, v43
    v_cvt_pk_bf16_f32 v40, v40, v41
    s_nop 0
    v_readlane_b32 s74, v40, 0
    v_readlane_b32 s75, v40, 32
    v_readlane_b32 s76, v40, 1
    v_readlane_b32 s77, v40, 33
    v_readlane_b32 s78, v40, 2
    v_readlane_b32 s79, v40, 34
    v_readlane_b32 s80, v40, 3
    v_readlane_b32 s81, v40, 35
    s_waitcnt lgkmcnt(0)
    v_dot2_f32_bf16 v48, s74, v192, 0
    v_dot2_f32_bf16 v49, s74, v194, 0
    v_dot2_f32_bf16 v48, s75, v193, v48
    v_dot2_f32_bf16 v49, s75, v195, v49
    v_dot2_f32_bf16 v48, s76, v196, v48
    v_dot2_f32_bf16 v49, s76, v198, v49
    v_dot2_f32_bf16 v48, s77, v197, v48
    v_dot2_f32_bf16 v49, s77, v199, v49
    v_dot2_f32_bf16 v48, s78, v200, v48
    v_dot2_f32_bf16 v49, s78, v202, v49
    v_dot2_f32_bf16 v48, s79, v201, v48
    v_dot2_f32_bf16 v49, s79, v203, v49
    v_dot2_f32_bf16 v48, s80, v204, v48
    v_dot2_f32_bf16 v49, s80, v206, v49
    v_dot2_f32_bf16 v48, s81, v205, v48
    v_dot2_f32_bf16 v49, s81, v207, v49
    s_cmp_lg_u32 s82, 3
    s_nop 1
    ds_write2_b32 v208, v48, v49 offset1:64
    s_waitcnt lgkmcnt(0)
    s_barrier
    s_cbranch_scc1 L_fin
    ds_read_b64 v[42:43], v209 offset:2048
    ds_read_b64 v[44:45], v209 offset:2560
    ds_read_b64 v[46:47], v209 offset:3072
    ds_read_b64 v[48:49], v209 offset:3584
    s_lshl2_add_u32 s70, s57, s14
    s_cmp_eq_u32 s70, 2
    s_waitcnt lgkmcnt(0)
    v_pk_add_f32 v[48:49], v[48:49], v[42:43]
    v_pk_add_f32 v[44:45], v[44:45], v[46:47]
    v_pk_add_f32 v[48:49], v[48:49], v[44:45]
    v_and_or_b32 v48, v48, -16, v12
    v_and_or_b32 v49, v49, -16, v13
    s_cbranch_scc1 L_t3
    buffer_store_dwordx2 v[48:49], v210, s[36:39], s25 offen sc1
    s_cmp_lg_u32 s57, 0
    s_cbranch_scc1 L_fin
    s_branch L_t3b
L_t3:
    buffer_store_dwordx2 v[48:49], v210, s[36:39], s25 offen
L_t3b:
    s_waitcnt vmcnt(0)
    s_lshr_b32 s28, s58, 1
    s_lshl_b32 s28, s28, 10
    s_and_b32 s72, s58, 1
    s_lshl_b32 s72, s72, 6
    s_add_u32 s28, s28, s72
    s_add_u32 s28, s28, 86016
    s_add_u32 s29, s28, 262144
    s_add_u32 s30, s28, 524288
    s_add_u32 s31, s28, 786432
    v_lshlrev_b32 v50, 16, v58
    v_and_b32 v51, s69, v58
    s_mov_b32 s40, s22
    s_mov_b32 s41, s23
    s_mov_b32 s42, 1024
    s_mov_b32 s43, 0x20000
    s_lshl_b32 s73, s58, 5
    s_mov_b32 s84, 0
    buffer_load_dwordx4 v[68:71], v214, s[36:39], s29 offen sc1
    buffer_load_dwordx4 v[72:75], v214, s[36:39], s30 offen sc1
    buffer_load_dwordx4 v[76:79], v214, s[36:39], s31 offen sc1
    buffer_load_dwordx4 v[64:67], v214, s[36:39], s28 offen sc1
L_h2poll:
    s_waitcnt vmcnt(0)
    v_xor_b32 v64, v8, v64
    v_xor_b32 v65, v9, v65
    v_xor_b32 v66, v10, v66
    v_xor_b32 v67, v11, v67
    v_xor_b32 v68, v8, v68
    v_xor_b32 v69, v9, v69
    v_xor_b32 v70, v10, v70
    v_xor_b32 v71, v11, v71
    v_xor_b32 v72, v8, v72
    v_xor_b32 v73, v9, v73
    v_xor_b32 v74, v10, v74
    v_xor_b32 v75, v11, v75
    v_xor_b32 v76, v8, v76
    v_xor_b32 v77, v9, v77
    v_xor_b32 v78, v10, v78
    v_xor_b32 v79, v11, v79
    v_or_b32 v14, v64, v65
    v_or3_b32 v14, v14, v66, v67
    v_or3_b32 v14, v14, v68, v69
    v_or3_b32 v14, v14, v70, v71
    v_or3_b32 v14, v14, v72, v73
    v_or3_b32 v14, v14, v74, v75
    v_or3_b32 v14, v14, v76, v77
    v_or3_b32 v14, v14, v78, v79
    v_and_b32 v14, 15, v14
    v_cmp_ne_u32 vcc, 0, v14
    s_cbranch_vccz L_h2ok
    buffer_load_dwordx4 v[64:67], v214, s[36:39], s28 offen sc1
    buffer_load_dwordx4 v[68:71], v214, s[36:39], s29 offen sc1
    buffer_load_dwordx4 v[72:75], v214, s[36:39], s30 offen sc1
    buffer_load_dwordx4 v[76:79], v214, s[36:39], s31 offen sc1
    s_add_u32 s84, s84, 1
    s_cmp_lt_u32 s84, s15
    s_cbranch_scc1 L_h2poll
L_h2ok:
    v_pk_add_f32 v[64:65], v[64:65], v[72:73]
    v_pk_add_f32 v[66:67], v[66:67], v[74:75]
    v_pk_add_f32 v[68:69], v[68:69], v[76:77]
    v_pk_add_f32 v[70:71], v[70:71], v[78:79]
    v_pk_add_f32 v[64:65], v[64:65], v[68:69]
    v_pk_add_f32 v[66:67], v[66:67], v[70:71]
    s_nop 1
    v_permlane32_swap_b32 v64, v66
    v_permlane32_swap_b32 v65, v67
    s_nop 0
    v_add_f32 v64, v64, v66
    v_add_f32 v65, v65, v67
    s_nop 0
    v_add_f32 v64, v64, v64 row_ror:8
    v_add_f32 v65, v65, v65 row_ror:8
    s_nop 0
    v_add_f32 v64, v64, v64 row_ror:4
    v_add_f32 v65, v65, v65 row_ror:4
    v_mov_b32 v66, v64
    v_mov_b32 v67, v65
    s_nop 0
    v_permlane16_swap_b32 v64, v66
    v_permlane16_swap_b32 v65, v67
    s_nop 0
    v_add_f32 v64, v64, v66
    v_add_f32 v65, v65, v67
    v_cvt_pk_bf16_f32 v64, v64, v65
    v_and_b32 v65, s69, v64
    v_lshlrev_b32 v64, 16, v64
    v_mul_f32 v64, v64, v56
    v_mul_f32 v65, v65, v57
    v_cvt_pk_bf16_f32 v64, v64, v65
    v_and_b32 v65, s69, v64
    v_lshlrev_b32 v64, 16, v64
    v_add_f32 v64, v64, v50
    v_add_f32 v65, v65, v51
    v_cvt_pk_bf16_f32 v64, v64, v65
    s_mov_b32 exec_lo, 15
    s_mov_b32 exec_hi, 15
    buffer_store_dword v64, v215, s[40:43], s73 offen
    s_cmp_lg_u32 s58, 0
    s_cbranch_scc1 L_fin
    s_mov_b64 exec, 1
    v_mov_b32 v65, s64
    s_mov_b32 s71, 126976
    buffer_store_dword v65, v7, s[36:39], s71 offen
L_fin:
L_end:
    s_endpgm
.section .rodata,"a"
.p2align 6
.amdhsa_kernel recurrent_scan__gqa_block_cached__glu_gated_glu__decode_kernel
  .amdhsa_next_free_vgpr 216
  .amdhsa_next_free_sgpr 102
  .amdhsa_accum_offset 216
  .amdhsa_group_segment_fixed_size 0
  .amdhsa_kernarg_size 96
  .amdhsa_user_sgpr_count 2
  .amdhsa_user_sgpr_kernarg_segment_ptr 1
  .amdhsa_system_sgpr_workgroup_id_x 1
.end_amdhsa_kernel
```
